```python
import torch

def _softmax(x, axis=-1):
    return torch.softmax(x, dim=axis)
def _gelu(x):
    return torch.nn.functional.gelu(x, approximate="tanh")
def _silu(x):
    return torch.nn.functional.silu(x)
def _sigmoid(x):
    return torch.sigmoid(x)
def _layernorm(x, axis=-1, eps=1e-5):
    m = x.mean(dim=axis, keepdim=True)
    v = x.var(dim=axis, keepdim=True, unbiased=False)
    return (x - m) / torch.sqrt(v + eps)
def _scatter_add(tgt, idx, src, axis=0):
    return tgt.clone().index_add_(axis, idx, src)
def _segment_sum(src, seg, n):
    out = torch.zeros((n,) + src.shape[1:], dtype=src.dtype)
    return out.index_add_(0, seg, src)
def _pad(x, pw):
    flat = tuple(v for pair in reversed(pw) for v in pair)
    return torch.nn.functional.pad(x, flat)

kernel_name = 'parallel_sum__sliding_block_cached__dense_activation_relu__decode'

def setup_inputs():

    _w = (lambda a: (lambda t: t.to(torch.bfloat16) if t.is_floating_point() else t)(torch.as_tensor(a)))
    def _A_setup():
        B, Sq, D = 1, 1, 640
        Hq, Hkv, Sk, Dh = 32, 32, 32768, 192
        assert Hq % Hkv == 0, (Hq, Hkv)
        return {
            "x": _w((lambda *s: torch.randn(*s, dtype=torch.bfloat16) * 0.05)(B, Sq, D)),
            "k_cache": _w((lambda *s: torch.randn(*s, dtype=torch.bfloat16) * 3.2)(B, Hkv, Sk, Dh)),
            "v_cache": _w((lambda *s: torch.randn(*s, dtype=torch.bfloat16) * 1.6)(B, Hkv, Sk, Dh)),
            "wq": _w((lambda *s: torch.randn(*s, dtype=torch.bfloat16) * 3.2)(D, Hq * Dh) * (D ** -0.5)),
            "wo": _w((lambda *s: torch.randn(*s, dtype=torch.bfloat16) * 1.6)(Hq * Dh, D) * ((Hq * Dh) ** -0.5)),
        }
    _A_in = _A_setup()

    def _B_setup():
        B, S, D, Dff = 1, 1, 640, 1536
        return {
            "x": _w((lambda *s: torch.randn(*s, dtype=torch.bfloat16) * 0.05)(B, S, D)),
            "w1": _w((lambda *s: torch.randn(*s, dtype=torch.bfloat16) * 0.05)(D, Dff)),
            "w2": _w((lambda *s: torch.randn(*s, dtype=torch.bfloat16) * 0.05)(Dff, D)),
        }
    _B_in = _B_setup()

    return {
        "A_x": _A_in["x"],
        "A_k_cache": _A_in["k_cache"],
        "A_v_cache": _A_in["v_cache"],
        "A_wq": _A_in["wq"],
        "A_wo": _A_in["wo"],
        "B_x": _B_in["x"],
        "B_w1": _B_in["w1"],
        "B_w2": _B_in["w2"],
    }

def reference(A_x, A_k_cache, A_v_cache, A_wq, A_wo, B_x, B_w1, B_w2):
    def _A_ref(x, k_cache, v_cache, wq, wo):
        B, Sq, D = x.shape
        Hq, Dh = 32, 192
        Hkv, Sk = k_cache.shape[1], k_cache.shape[2]
        W = min(4096, max(256, Sk // 4))
        rep = Hq // Hkv
        q = (lambda x, *d: x.permute(*d))((x @ wq).reshape(B, Sq, Hq, Dh), 0, 2, 1, 3)
        k = (lambda x, n, axis: torch.repeat_interleave(x, n, dim=axis))(k_cache[:, :, Sk - W:, :], rep, axis=1)
        v = (lambda x, n, axis: torch.repeat_interleave(x, n, dim=axis))(v_cache[:, :, Sk - W:, :], rep, axis=1)
        scores = torch.einsum("bhqd,bhkd->bhqk", q, k) * (Dh ** -0.5)
        p = _softmax(scores, axis=-1)
        o = torch.einsum("bhqk,bhkd->bhqd", p, v)
        return (lambda x, *d: x.permute(*d))(o, 0, 2, 1, 3).reshape(B, Sq, Hq * Dh) @ wo

    def _B_ref(x, w1, w2):
        h = torch.einsum("bsd,df->bsf", x, w1)
        zero = torch.zeros_like(h)
        h = torch.maximum(h, zero)
        return torch.einsum("bsf,fd->bsd", h, w2)

    x = A_x
    xn = _layernorm(x, axis=-1)
    return x + _A_ref(xn, A_k_cache, A_v_cache, A_wq, A_wo) + _B_ref(xn, B_w1, B_w2)
```

```asm
; @launch grid=(256,1,1) block=(1024,1,1) lds=86848
.amdgcn_target "amdgcn-amd-amdhsa--gfx950"
.text
.globl parallel_sum__sliding_block_cached__dense_activation_relu__decode_kernel
.p2align 8
.type parallel_sum__sliding_block_cached__dense_activation_relu__decode_kernel,@function
parallel_sum__sliding_block_cached__dense_activation_relu__decode_kernel:
    s_cmp_ge_u32 s2, 256
    s_cbranch_scc1 L_end
    s_load_dwordx16 s[4:19], s[0:1], 0
    s_load_dwordx4 s[20:23], s[0:1], 64
    s_load_dwordx2 s[24:25], s[0:1], 80
    v_and_b32 v1, 63, v0
    v_and_b32 v2, 15, v0
    v_bfe_u32 v3, v0, 4, 2
    v_lshrrev_b32 v6, 6, v0
    s_nop 0
    v_readfirstlane_b32 s64, v6
    s_and_b32 s65, s2, 7
    s_lshr_b32 s66, s2, 3
    s_lshr_b32 s74, s66, 3
    s_lshl_b32 s67, s65, 2
    s_add_u32 s67, s67, s74
    s_and_b32 s68, s66, 7
    s_lshl_b32 s69, s67, 3
    s_add_u32 s69, s69, s68
    v_lshlrev_b32 v6, 4, v2
    v_lshlrev_b32 v7, 3, v2
    v_add_u32 v7, 256, v7
    v_mul_u32_u24 v8, 384, v3
    v_add_u32 v4, v6, v8
    v_add_u32 v5, v7, v8
    s_mul_i32 s75, s67, 12582912
    s_mul_i32 s74, s68, 196608
    s_add_u32 s75, s75, s74
    s_mul_i32 s74, s64, 12288
    s_add_u32 s75, s75, s74
    s_add_u32 s75, s75, 11010048
    s_add_u32 s76, s75, 4608
    s_add_u32 s77, s75, 9216
    s_lshl_b32 s82, s69, 11
    s_add_u32 s85, s82, 1048576
    s_add_u32 s82, s82, 524288
    s_mul_i32 s83, s65, 163840
    s_lshl_b32 s74, s66, 7
    s_add_u32 s83, s83, s74
    s_add_u32 s84, s83, 4194304
    s_add_u32 s83, s83, 2097152
    v_mov_b32 v14, 0
    s_cmp_lt_u32 s64, 4
    s_cbranch_scc1 L_front
    v_mov_b32 v15, 0
    ds_write_b64 v14, v[14:15] offset:18624
    ds_write_b64 v14, v[14:15] offset:18632
    s_waitcnt lgkmcnt(0)
    s_load_dword s26, s[24:25], 0
    s_mov_b32 s32, s6
    s_and_b32 s33, s7, 0xffff
    s_mov_b32 s34, 402653184
    s_mov_b32 s35, 0x20000
    s_barrier
    s_branch L_join
L_front:
    s_nop 4
    v_mul_u32_u24 v8, 61440, v3
    v_add_u32 v11, v6, v8
    v_add_u32 v12, v7, v8
    v_mul_u32_u24 v9, 20, v1
    v_mul_u32_u24 v8, 3072, v3
    v_add_u32 v10, v6, v8
    v_add_u32 v13, v7, v8
    s_mul_i32 s78, s67, 384
    s_mul_i32 s74, s64, 245760
    s_add_u32 s78, s78, s74
    s_mul_i32 s74, s68, 983040
    s_add_u32 s78, s78, s74
    s_mul_i32 s88, s66, 20
    s_mul_i32 s86, s88, 3072
    s_mul_i32 s74, s65, 384
    s_add_u32 s86, s86, s74
    s_add_u32 s87, s86, 49152
    s_mul_i32 s74, s64, 12288
    s_add_u32 s79, s86, s74
    s_cmp_eq_u32 s64, 0
    s_cselect_b32 s87, s87, 0x70000000
    s_lshl_b32 s89, s69, 11
    s_add_u32 s89, s89, 6291456
    s_waitcnt lgkmcnt(0)
    s_load_dword s26, s[24:25], 0
    s_mov_b32 s28, s4
    s_and_b32 s29, s5, 0xffff
    s_mov_b32 s30, 1280
    s_mov_b32 s31, 0x20000
    s_mov_b32 s48, s16
    s_and_b32 s49, s17, 0xffff
    s_mov_b32 s50, 1966080
    s_mov_b32 s51, 0x20000
    s_mov_b32 s40, s10
    s_and_b32 s41, s11, 0xffff
    s_mov_b32 s42, 7864320
    s_mov_b32 s43, 0x20000
    buffer_load_dwordx4 v[120:123], v9, s[28:31], 0 offen
    buffer_load_dword v124, v9, s[28:31], 0 offen offset:16
    buffer_load_dwordx4 v[72:75], v10, s[48:51], s79 offen nt
    buffer_load_dwordx2 v[76:77], v13, s[48:51], s79 offen nt
    buffer_load_dwordx4 v[78:81], v10, s[48:51], s87 offen nt
    buffer_load_dwordx2 v[82:83], v13, s[48:51], s87 offen nt
    buffer_load_dwordx4 v[84:87], v11, s[40:43], s78 offen nt
    buffer_load_dwordx2 v[88:89], v12, s[40:43], s78 offen nt
    s_add_u32 s78, s78, 12288
    buffer_load_dwordx4 v[90:93], v11, s[40:43], s78 offen nt
    buffer_load_dwordx2 v[94:95], v12, s[40:43], s78 offen nt
    s_add_u32 s78, s78, 12288
    buffer_load_dwordx4 v[96:99], v11, s[40:43], s78 offen nt
    buffer_load_dwordx2 v[100:101], v12, s[40:43], s78 offen nt
    s_add_u32 s78, s78, 12288
    buffer_load_dwordx4 v[102:105], v11, s[40:43], s78 offen nt
    buffer_load_dwordx2 v[106:107], v12, s[40:43], s78 offen nt
    s_add_u32 s78, s78, 12288
    buffer_load_dwordx4 v[108:111], v11, s[40:43], s78 offen nt
    buffer_load_dwordx2 v[112:113], v12, s[40:43], s78 offen nt
    s_barrier
    s_mov_b32 s32, s6
    s_and_b32 s33, s7, 0xffff
    s_mov_b32 s34, 402653184
    s_mov_b32 s35, 0x20000
    s_mov_b32 s60, s24
    s_and_b32 s61, s25, 0xffff
    s_mov_b32 s62, 1610612736
    s_mov_b32 s63, 0x20000
    s_mov_b32 s80, 0x44200000
    s_mov_b32 s81, 0x3acccccd
    s_waitcnt vmcnt(14)
    v_lshlrev_b32 v6, 16, v120
    v_and_b32 v7, 0xffff0000, v120
    v_lshlrev_b32 v8, 16, v121
    v_and_b32 v9, 0xffff0000, v121
    v_lshlrev_b32 v10, 16, v122
    v_and_b32 v11, 0xffff0000, v122
    v_lshlrev_b32 v12, 16, v123
    v_and_b32 v13, 0xffff0000, v123
    v_lshlrev_b32 v14, 16, v124
    v_and_b32 v15, 0xffff0000, v124
    v_add_f32 v16, v6, v7
    v_add_f32 v16, v16, v8
    v_add_f32 v16, v16, v9
    v_add_f32 v16, v16, v10
    v_add_f32 v16, v16, v11
    v_add_f32 v16, v16, v12
    v_add_f32 v16, v16, v13
    v_add_f32 v16, v16, v14
    v_add_f32 v16, v16, v15
    s_nop 1
    v_add_f32_dpp v16, v16, v16 quad_perm:[1,0,3,2] row_mask:0xf bank_mask:0xf
    s_nop 1
    v_add_f32_dpp v16, v16, v16 quad_perm:[2,3,0,1] row_mask:0xf bank_mask:0xf
    s_nop 1
    v_add_f32_dpp v16, v16, v16 row_half_mirror row_mask:0xf bank_mask:0xf
    s_nop 1
    v_add_f32_dpp v16, v16, v16 row_mirror row_mask:0xf bank_mask:0xf
    v_mov_b32 v17, v16
    s_nop 1
    v_permlane16_swap_b32 v16, v17
    v_add_f32 v16, v16, v17
    v_mov_b32 v17, v16
    s_nop 1
    v_permlane32_swap_b32 v16, v17
    v_add_f32 v16, v16, v17
    v_mul_f32 v17, s81, v16
    v_fma_f32 v16, -v17, s80, v16
    v_fma_f32 v16, v16, s81, v17
    v_sub_f32 v17, v6, v16
    v_mul_f32 v18, v17, v17
    v_sub_f32 v17, v7, v16
    v_fmac_f32 v18, v17, v17
    v_sub_f32 v17, v8, v16
    v_fmac_f32 v18, v17, v17
    v_sub_f32 v17, v9, v16
    v_fmac_f32 v18, v17, v17
    v_sub_f32 v17, v10, v16
    v_fmac_f32 v18, v17, v17
    v_sub_f32 v17, v11, v16
    v_fmac_f32 v18, v17, v17
    v_sub_f32 v17, v12, v16
    v_fmac_f32 v18, v17, v17
    v_sub_f32 v17, v13, v16
    v_fmac_f32 v18, v17, v17
    v_sub_f32 v17, v14, v16
    v_fmac_f32 v18, v17, v17
    v_sub_f32 v17, v15, v16
    v_fmac_f32 v18, v17, v17
    s_nop 1
    v_add_f32_dpp v18, v18, v18 quad_perm:[1,0,3,2] row_mask:0xf bank_mask:0xf
    s_nop 1
    v_add_f32_dpp v18, v18, v18 quad_perm:[2,3,0,1] row_mask:0xf bank_mask:0xf
    s_nop 1
    v_add_f32_dpp v18, v18, v18 row_half_mirror row_mask:0xf bank_mask:0xf
    s_nop 1
    v_add_f32_dpp v18, v18, v18 row_mirror row_mask:0xf bank_mask:0xf
    v_mov_b32 v17, v18
    s_nop 1
    v_permlane16_swap_b32 v18, v17
    v_add_f32 v18, v18, v17
    v_mov_b32 v17, v18
    s_nop 1
    v_permlane32_swap_b32 v18, v17
    v_add_f32 v18, v18, v17
    v_mul_f32 v17, s81, v18
    v_fma_f32 v18, -v17, s80, v18
    v_fma_f32 v18, v18, s81, v17
    v_cvt_pk_bf16_f32 v17, v16, v18
    v_lshlrev_b32 v16, 16, v17
    v_and_b32 v18, 0xffff0000, v17
    v_add_f32 v18, 0x3727c5ac, v18
    v_cvt_pk_bf16_f32 v17, v18, v19
    v_lshlrev_b32 v18, 16, v17
    v_and_b32 v19, 0xffff0000, v17
    v_sqrt_f32 v18, v18
    s_nop 0
    v_cvt_pk_bf16_f32 v17, v18, v19
    v_lshlrev_b32 v18, 16, v17
    v_and_b32 v19, 0xffff0000, v17
    v_rcp_f32 v19, v18
    v_mul_u32_u24 v20, 40, v1
    v_sub_f32 v6, v6, v16
    v_sub_f32 v7, v7, v16
    v_cvt_pk_bf16_f32 v17, v6, v7
    v_lshlrev_b32 v6, 16, v17
    v_and_b32 v7, 0xffff0000, v17
    v_mul_f32 v21, v6, v19
    v_fma_f32 v22, -v21, v18, v6
    v_fma_f32 v6, v22, v19, v21
    v_mul_f32 v21, v7, v19
    v_fma_f32 v22, -v21, v18, v7
    v_fma_f32 v7, v22, v19, v21
    v_cvt_pk_bf16_f32 v17, v6, v7
    v_lshlrev_b32 v6, 16, v17
    v_and_b32 v7, 0xffff0000, v17
    ds_write_b64 v20, v[6:7] offset:0
    v_sub_f32 v8, v8, v16
    v_sub_f32 v9, v9, v16
    v_cvt_pk_bf16_f32 v17, v8, v9
    v_lshlrev_b32 v8, 16, v17
    v_and_b32 v9, 0xffff0000, v17
    v_mul_f32 v21, v8, v19
    v_fma_f32 v22, -v21, v18, v8
    v_fma_f32 v8, v22, v19, v21
    v_mul_f32 v21, v9, v19
    v_fma_f32 v22, -v21, v18, v9
    v_fma_f32 v9, v22, v19, v21
    v_cvt_pk_bf16_f32 v17, v8, v9
    v_lshlrev_b32 v8, 16, v17
    v_and_b32 v9, 0xffff0000, v17
    ds_write_b64 v20, v[8:9] offset:8
    v_sub_f32 v10, v10, v16
    v_sub_f32 v11, v11, v16
    v_cvt_pk_bf16_f32 v17, v10, v11
    v_lshlrev_b32 v10, 16, v17
    v_and_b32 v11, 0xffff0000, v17
    v_mul_f32 v21, v10, v19
    v_fma_f32 v22, -v21, v18, v10
    v_fma_f32 v10, v22, v19, v21
    v_mul_f32 v21, v11, v19
    v_fma_f32 v22, -v21, v18, v11
    v_fma_f32 v11, v22, v19, v21
    v_cvt_pk_bf16_f32 v17, v10, v11
    v_lshlrev_b32 v10, 16, v17
    v_and_b32 v11, 0xffff0000, v17
    ds_write_b64 v20, v[10:11] offset:16
    v_sub_f32 v12, v12, v16
    v_sub_f32 v13, v13, v16
    v_cvt_pk_bf16_f32 v17, v12, v13
    v_lshlrev_b32 v12, 16, v17
    v_and_b32 v13, 0xffff0000, v17
    v_mul_f32 v21, v12, v19
    v_fma_f32 v22, -v21, v18, v12
    v_fma_f32 v12, v22, v19, v21
    v_mul_f32 v21, v13, v19
    v_fma_f32 v22, -v21, v18, v13
    v_fma_f32 v13, v22, v19, v21
    v_cvt_pk_bf16_f32 v17, v12, v13
    v_lshlrev_b32 v12, 16, v17
    v_and_b32 v13, 0xffff0000, v17
    ds_write_b64 v20, v[12:13] offset:24
    v_sub_f32 v14, v14, v16
    v_sub_f32 v15, v15, v16
    v_cvt_pk_bf16_f32 v17, v14, v15
    v_lshlrev_b32 v14, 16, v17
    v_and_b32 v15, 0xffff0000, v17
    v_mul_f32 v21, v14, v19
    v_fma_f32 v22, -v21, v18, v14
    v_fma_f32 v14, v22, v19, v21
    v_mul_f32 v21, v15, v19
    v_fma_f32 v22, -v21, v18, v15
    v_fma_f32 v15, v22, v19, v21
    v_cvt_pk_bf16_f32 v17, v14, v15
    v_lshlrev_b32 v14, 16, v17
    v_and_b32 v15, 0xffff0000, v17
    ds_write_b64 v20, v[14:15] offset:32
    s_lshl_b32 s74, s88, 2
    v_lshlrev_b32 v21, 2, v3
    v_add_u32 v21, s74, v21
    s_lshl_b32 s74, s64, 4
    v_add_u32 v23, s74, v21
    s_mul_i32 s74, s68, 320
    s_mul_i32 s93, s64, 80
    s_add_u32 s74, s74, s93
    v_mul_u32_u24 v22, 20, v3
    v_add_u32 v22, s74, v22
    s_waitcnt lgkmcnt(0)
    s_add_u32 s26, s26, 1
    ds_read_b32 v114, v23 offset:0
    ds_read_b32 v115, v21 offset:64
    ds_read_b32 v120, v22 offset:0
    ds_read_b32 v121, v22 offset:4
    ds_read_b32 v122, v22 offset:8
    ds_read_b32 v123, v22 offset:12
    ds_read_b32 v124, v22 offset:16
    s_waitcnt vmcnt(10)
    s_waitcnt lgkmcnt(0)
    v_lshlrev_b32 v21, 16, v72
    v_and_b32 v22, 0xffff0000, v72
    v_mul_f32 v6, v114, v21
    v_mul_f32 v7, v114, v22
    v_lshlrev_b32 v21, 16, v73
    v_and_b32 v22, 0xffff0000, v73
    v_mul_f32 v8, v114, v21
    v_mul_f32 v9, v114, v22
    v_lshlrev_b32 v21, 16, v74
    v_and_b32 v22, 0xffff0000, v74
    v_mul_f32 v10, v114, v21
    v_mul_f32 v11, v114, v22
    v_lshlrev_b32 v21, 16, v75
    v_and_b32 v22, 0xffff0000, v75
    v_mul_f32 v12, v114, v21
    v_mul_f32 v13, v114, v22
    v_lshlrev_b32 v21, 16, v76
    v_and_b32 v22, 0xffff0000, v76
    v_mul_f32 v14, v114, v21
    v_mul_f32 v15, v114, v22
    v_lshlrev_b32 v21, 16, v77
    v_and_b32 v22, 0xffff0000, v77
    v_mul_f32 v16, v114, v21
    v_mul_f32 v17, v114, v22
    v_lshlrev_b32 v21, 16, v78
    v_and_b32 v22, 0xffff0000, v78
    v_fmac_f32 v6, v115, v21
    v_fmac_f32 v7, v115, v22
    v_lshlrev_b32 v21, 16, v79
    v_and_b32 v22, 0xffff0000, v79
    v_fmac_f32 v8, v115, v21
    v_fmac_f32 v9, v115, v22
    v_lshlrev_b32 v21, 16, v80
    v_and_b32 v22, 0xffff0000, v80
    v_fmac_f32 v10, v115, v21
    v_fmac_f32 v11, v115, v22
    v_lshlrev_b32 v21, 16, v81
    v_and_b32 v22, 0xffff0000, v81
    v_fmac_f32 v12, v115, v21
    v_fmac_f32 v13, v115, v22
    v_lshlrev_b32 v21, 16, v82
    v_and_b32 v22, 0xffff0000, v82
    v_fmac_f32 v14, v115, v21
    v_fmac_f32 v15, v115, v22
    v_lshlrev_b32 v21, 16, v83
    v_and_b32 v22, 0xffff0000, v83
    v_fmac_f32 v16, v115, v21
    v_fmac_f32 v17, v115, v22
    v_permlane32_swap_b32 v6, v7
    v_permlane32_swap_b32 v8, v9
    v_permlane32_swap_b32 v10, v11
    v_permlane32_swap_b32 v12, v13
    v_permlane32_swap_b32 v14, v15
    v_permlane32_swap_b32 v16, v17
    v_add_f32 v6, v6, v7
    v_add_f32 v8, v8, v9
    v_add_f32 v10, v10, v11
    v_add_f32 v12, v12, v13
    v_add_f32 v14, v14, v15
    v_add_f32 v16, v16, v17
    v_permlane16_swap_b32 v6, v8
    v_permlane16_swap_b32 v10, v12
    v_permlane16_swap_b32 v14, v16
    v_add_f32 v6, v6, v8
    v_add_f32 v10, v10, v12
    v_add_f32 v14, v14, v16
    v_and_b32 v18, 1, v3
    v_lshlrev_b32 v18, 1, v18
    v_lshrrev_b32 v19, 1, v3
    v_or_b32 v18, v18, v19
    v_lshlrev_b32 v18, 2, v18
    s_mul_i32 s74, s64, 768
    v_add_u32 v18, s74, v18
    v_lshl_add_u32 v19, v2, 4, v18
    v_lshl_add_u32 v18, v2, 5, v18
    ds_write_b32 v18, v6 offset:14848
    ds_write_b32 v18, v10 offset:14864
    ds_write_b32 v19, v14 offset:15360
    s_waitcnt vmcnt(8)
    v_lshlrev_b32 v125, 16, v84
    v_and_b32 v126, 0xffff0000, v84
    v_mul_f32 v6, v120, v125
    v_mul_f32 v7, v120, v126
    v_lshlrev_b32 v125, 16, v85
    v_and_b32 v126, 0xffff0000, v85
    v_mul_f32 v8, v120, v125
    v_mul_f32 v9, v120, v126
    v_lshlrev_b32 v125, 16, v86
    v_and_b32 v126, 0xffff0000, v86
    v_mul_f32 v10, v120, v125
    v_mul_f32 v11, v120, v126
    v_lshlrev_b32 v125, 16, v87
    v_and_b32 v126, 0xffff0000, v87
    v_mul_f32 v12, v120, v125
    v_mul_f32 v13, v120, v126
    v_lshlrev_b32 v125, 16, v88
    v_and_b32 v126, 0xffff0000, v88
    v_mul_f32 v14, v120, v125
    v_mul_f32 v15, v120, v126
    v_lshlrev_b32 v125, 16, v89
    v_and_b32 v126, 0xffff0000, v89
    v_mul_f32 v16, v120, v125
    v_mul_f32 v17, v120, v126
    s_waitcnt vmcnt(6)
    v_lshlrev_b32 v125, 16, v90
    v_and_b32 v126, 0xffff0000, v90
    v_fmac_f32 v6, v121, v125
    v_fmac_f32 v7, v121, v126
    v_lshlrev_b32 v125, 16, v91
    v_and_b32 v126, 0xffff0000, v91
    v_fmac_f32 v8, v121, v125
    v_fmac_f32 v9, v121, v126
    v_lshlrev_b32 v125, 16, v92
    v_and_b32 v126, 0xffff0000, v92
    v_fmac_f32 v10, v121, v125
    v_fmac_f32 v11, v121, v126
    v_lshlrev_b32 v125, 16, v93
    v_and_b32 v126, 0xffff0000, v93
    v_fmac_f32 v12, v121, v125
    v_fmac_f32 v13, v121, v126
    v_lshlrev_b32 v125, 16, v94
    v_and_b32 v126, 0xffff0000, v94
    v_fmac_f32 v14, v121, v125
    v_fmac_f32 v15, v121, v126
    v_lshlrev_b32 v125, 16, v95
    v_and_b32 v126, 0xffff0000, v95
    v_fmac_f32 v16, v121, v125
    v_fmac_f32 v17, v121, v126
    s_waitcnt vmcnt(4)
    v_lshlrev_b32 v125, 16, v96
    v_and_b32 v126, 0xffff0000, v96
    v_fmac_f32 v6, v122, v125
    v_fmac_f32 v7, v122, v126
    v_lshlrev_b32 v125, 16, v97
    v_and_b32 v126, 0xffff0000, v97
    v_fmac_f32 v8, v122, v125
    v_fmac_f32 v9, v122, v126
    v_lshlrev_b32 v125, 16, v98
    v_and_b32 v126, 0xffff0000, v98
    v_fmac_f32 v10, v122, v125
    v_fmac_f32 v11, v122, v126
    v_lshlrev_b32 v125, 16, v99
    v_and_b32 v126, 0xffff0000, v99
    v_fmac_f32 v12, v122, v125
    v_fmac_f32 v13, v122, v126
    v_lshlrev_b32 v125, 16, v100
    v_and_b32 v126, 0xffff0000, v100
    v_fmac_f32 v14, v122, v125
    v_fmac_f32 v15, v122, v126
    v_lshlrev_b32 v125, 16, v101
    v_and_b32 v126, 0xffff0000, v101
    v_fmac_f32 v16, v122, v125
    v_fmac_f32 v17, v122, v126
    s_waitcnt vmcnt(2)
    v_lshlrev_b32 v125, 16, v102
    v_and_b32 v126, 0xffff0000, v102
    v_fmac_f32 v6, v123, v125
    v_fmac_f32 v7, v123, v126
    v_lshlrev_b32 v125, 16, v103
    v_and_b32 v126, 0xffff0000, v103
    v_fmac_f32 v8, v123, v125
    v_fmac_f32 v9, v123, v126
    v_lshlrev_b32 v125, 16, v104
    v_and_b32 v126, 0xffff0000, v104
    v_fmac_f32 v10, v123, v125
    v_fmac_f32 v11, v123, v126
    v_lshlrev_b32 v125, 16, v105
    v_and_b32 v126, 0xffff0000, v105
    v_fmac_f32 v12, v123, v125
    v_fmac_f32 v13, v123, v126
    v_lshlrev_b32 v125, 16, v106
    v_and_b32 v126, 0xffff0000, v106
    v_fmac_f32 v14, v123, v125
    v_fmac_f32 v15, v123, v126
    v_lshlrev_b32 v125, 16, v107
    v_and_b32 v126, 0xffff0000, v107
    v_fmac_f32 v16, v123, v125
    v_fmac_f32 v17, v123, v126
    s_waitcnt vmcnt(0)
    v_lshlrev_b32 v125, 16, v108
    v_and_b32 v126, 0xffff0000, v108
    v_fmac_f32 v6, v124, v125
    v_fmac_f32 v7, v124, v126
    v_lshlrev_b32 v125, 16, v109
    v_and_b32 v126, 0xffff0000, v109
    v_fmac_f32 v8, v124, v125
    v_fmac_f32 v9, v124, v126
    v_lshlrev_b32 v125, 16, v110
    v_and_b32 v126, 0xffff0000, v110
    v_fmac_f32 v10, v124, v125
    v_fmac_f32 v11, v124, v126
    v_lshlrev_b32 v125, 16, v111
    v_and_b32 v126, 0xffff0000, v111
    v_fmac_f32 v12, v124, v125
    v_fmac_f32 v13, v124, v126
    v_lshlrev_b32 v125, 16, v112
    v_and_b32 v126, 0xffff0000, v112
    v_fmac_f32 v14, v124, v125
    v_fmac_f32 v15, v124, v126
    v_lshlrev_b32 v125, 16, v113
    v_and_b32 v126, 0xffff0000, v113
    v_fmac_f32 v16, v124, v125
    v_fmac_f32 v17, v124, v126
    v_permlane32_swap_b32 v6, v7
    v_permlane32_swap_b32 v8, v9
    v_permlane32_swap_b32 v10, v11
    v_permlane32_swap_b32 v12, v13
    v_permlane32_swap_b32 v14, v15
    v_permlane32_swap_b32 v16, v17
    v_add_f32 v6, v6, v7
    v_add_f32 v8, v8, v9
    v_add_f32 v10, v10, v11
    v_add_f32 v12, v12, v13
    v_add_f32 v14, v14, v15
    v_add_f32 v16, v16, v17
    v_permlane16_swap_b32 v6, v8
    v_permlane16_swap_b32 v10, v12
    v_permlane16_swap_b32 v14, v16
    v_add_f32 v6, v6, v8
    v_add_f32 v10, v10, v12
    v_add_f32 v14, v14, v16
    v_and_b32 v18, 1, v3
    v_lshlrev_b32 v18, 1, v18
    v_lshrrev_b32 v19, 1, v3
    v_or_b32 v18, v18, v19
    v_lshlrev_b32 v18, 2, v18
    s_mul_i32 s74, s64, 768
    v_add_u32 v18, s74, v18
    v_lshl_add_u32 v19, v2, 4, v18
    v_lshl_add_u32 v18, v2, 5, v18
    ds_write_b32 v18, v6 offset:2560
    ds_write_b32 v18, v10 offset:2576
    ds_write_b32 v19, v14 offset:3072
    v_mov_b32 v20, 0
    v_mov_b32 v21, 1
    s_waitcnt lgkmcnt(0)
    s_mov_b64 exec, 1
    ds_add_rtn_u32 v22, v20, v21 offset:18624
    s_waitcnt lgkmcnt(0)
    s_mov_b64 exec, -1
    v_readfirstlane_b32 s74, v22
    s_nop 3
    s_cmp_lg_u32 s74, 3
    s_cbranch_scc1 L_front_done
    s_getreg_b32 s70, hwreg(HW_REG_XCC_ID)
    s_and_b32 s70, s70, 7
    s_xor_b32 s70, s70, s26
    v_lshlrev_b32 v72, 3, v1
    ds_read_b64 v[76:77], v72 offset:2560
    ds_read_b64 v[84:85], v72 offset:3072
    ds_read_b64 v[92:93], v72 offset:14848
    ds_read_b64 v[100:101], v72 offset:15360
    ds_read_b64 v[78:79], v72 offset:3328
    ds_read_b64 v[86:87], v72 offset:3840
    ds_read_b64 v[94:95], v72 offset:15616
    ds_read_b64 v[102:103], v72 offset:16128
    ds_read_b64 v[80:81], v72 offset:4096
    ds_read_b64 v[88:89], v72 offset:4608
    ds_read_b64 v[96:97], v72 offset:16384
    ds_read_b64 v[104:105], v72 offset:16896
    ds_read_b64 v[82:83], v72 offset:4864
    ds_read_b64 v[90:91], v72 offset:5376
    ds_read_b64 v[98:99], v72 offset:17152
    ds_read_b64 v[106:107], v72 offset:17664
    s_waitcnt lgkmcnt(0)
    v_add_f32 v76, v76, v78
    v_add_f32 v80, v80, v82
    v_add_f32 v77, v77, v79
    v_add_f32 v81, v81, v83
    v_add_f32 v78, v77, v81
    v_add_f32 v76, v76, v80
    v_mov_b32 v77, s26
    v_mov_b32 v79, s70
    v_add_f32 v84, v84, v86
    v_add_f32 v88, v88, v90
    v_add_f32 v85, v85, v87
    v_add_f32 v89, v89, v91
    v_add_f32 v86, v85, v89
    v_add_f32 v84, v84, v88
    v_mov_b32 v85, s26
    v_mov_b32 v87, s70
    v_add_f32 v92, v92, v94
    v_add_f32 v96, v96, v98
    v_add_f32 v93, v93, v95
    v_add_f32 v97, v97, v99
    v_add_f32 v94, v93, v97
    v_add_f32 v92, v92, v96
    v_mov_b32 v93, s26
    v_mov_b32 v95, s70
    v_add_f32 v100, v100, v102
    v_add_f32 v104, v104, v106
    v_add_f32 v101, v101, v103
    v_add_f32 v105, v105, v107
    v_add_f32 v102, v101, v105
    v_add_f32 v100, v100, v104
    v_mov_b32 v101, s26
    v_mov_b32 v103, s70
    v_lshlrev_b32 v72, 4, v1
    v_mov_b32 v73, 0x70000000
    v_cmp_gt_u32 vcc, 32, v1
    s_nop 1
    v_cndmask_b32 v73, v73, v72, vcc
    buffer_store_dwordx4 v[76:79], v72, s[60:63], s85 offen
    buffer_store_dwordx4 v[84:87], v73, s[60:63], s85 offen offset:1024
    buffer_store_dwordx4 v[92:95], v72, s[60:63], s89 offen
    buffer_store_dwordx4 v[100:103], v73, s[60:63], s89 offen offset:1024
    ds_write_b128 v72, v[76:79] offset:51008
    ds_write_b128 v72, v[84:87] offset:52032
    ds_write_b128 v72, v[92:95] offset:53056
    ds_write_b128 v72, v[100:103] offset:54080
    v_mov_b32 v73, 0
    v_mov_b32 v74, 1
    s_waitcnt lgkmcnt(0)
    ds_write_b32 v73, v74 offset:18636
    s_waitcnt lgkmcnt(0)
L_front_done:
    s_nop 4
    s_sub_u32 s26, s26, 1
L_join:
    s_nop 4
    buffer_load_dwordx4 v[24:27], v4, s[32:35], s75 offen offset:0 nt
    buffer_load_dwordx2 v[28:29], v5, s[32:35], s75 offen offset:0 nt
    buffer_load_dwordx4 v[30:33], v4, s[32:35], s75 offen offset:1536 nt
    buffer_load_dwordx2 v[34:35], v5, s[32:35], s75 offen offset:1536 nt
    buffer_load_dwordx4 v[36:39], v4, s[32:35], s75 offen offset:3072 nt
    buffer_load_dwordx2 v[40:41], v5, s[32:35], s75 offen offset:3072 nt
    buffer_load_dwordx4 v[42:45], v4, s[32:35], s76 offen offset:0 nt
    buffer_load_dwordx2 v[46:47], v5, s[32:35], s76 offen offset:0 nt
    buffer_load_dwordx4 v[48:51], v4, s[32:35], s76 offen offset:1536 nt
    buffer_load_dwordx2 v[52:53], v5, s[32:35], s76 offen offset:1536 nt
    buffer_load_dwordx4 v[54:57], v4, s[32:35], s76 offen offset:3072 nt
    buffer_load_dwordx2 v[58:59], v5, s[32:35], s76 offen offset:3072 nt
    buffer_load_dwordx4 v[60:63], v4, s[32:35], s77 offen offset:0 nt
    buffer_load_dwordx2 v[64:65], v5, s[32:35], s77 offen offset:0 nt
    buffer_load_dwordx4 v[66:69], v4, s[32:35], s77 offen offset:1536 nt
    buffer_load_dwordx2 v[70:71], v5, s[32:35], s77 offen offset:1536 nt
    s_mov_b32 s28, s4
    s_and_b32 s29, s5, 0xffff
    s_mov_b32 s30, 1280
    s_mov_b32 s31, 0x20000
    s_mov_b32 s36, s8
    s_and_b32 s37, s9, 0xffff
    s_mov_b32 s38, 402653184
    s_mov_b32 s39, 0x20000
    s_mov_b32 s44, s12
    s_and_b32 s45, s13, 0xffff
    s_mov_b32 s46, 7864320
    s_mov_b32 s47, 0x20000
    s_mov_b32 s52, s18
    s_and_b32 s53, s19, 0xffff
    s_mov_b32 s54, 1966080
    s_mov_b32 s55, 0x20000
    s_mov_b32 s56, s20
    s_and_b32 s57, s21, 0xffff
    s_mov_b32 s58, 1280
    s_mov_b32 s59, 0x20000
    s_mov_b32 s60, s24
    s_and_b32 s61, s25, 0xffff
    s_mov_b32 s62, 1610612736
    s_mov_b32 s63, 0x20000
    s_waitcnt lgkmcnt(0)
    s_add_u32 s26, s26, 1
    s_not_b32 s27, s26
    v_mov_b32 v124, 0
    v_mov_b32 v125, s27
    v_lshlrev_b32 v126, 3, v0
    v_mov_b32 v20, 0x70000000
    v_lshlrev_b32 v21, 4, v0
    v_cmp_gt_u32 vcc, 960, v0
    s_nop 1
    v_cndmask_b32 v22, v20, v21, vcc
    s_mul_i32 s86, s69, 30720
    s_add_u32 s87, s86, 15360
    s_lshl_b32 s74, s64, 10
    s_add_u32 s74, s74, 55104
    s_add_u32 s79, s74, 15360
    s_cmp_eq_u32 s64, 15
    s_cselect_b32 s74, 85824, s74
    s_cselect_b32 s79, 85824, s79
    s_mov_b32 m0, s74
    s_nop 1
    buffer_load_dwordx4 v22, s[44:47], s86 offen nt lds
    s_mov_b32 m0, s79
    s_nop 1
    buffer_load_dwordx4 v22, s[44:47], s87 offen nt lds
    v_lshlrev_b32 v21, 4, v0
    v_cmp_gt_u32 vcc, 480, v0
    s_nop 1
    v_cndmask_b32 v21, v20, v21, vcc
    s_mul_i32 s74, s69, 7680
    s_nop 1
    buffer_load_dwordx4 v[124:127], v21, s[52:55], s74 offen nt
    buffer_load_dwordx4 v[72:75], v4, s[36:39], s75 offen offset:0 nt
    buffer_load_dwordx2 v[76:77], v5, s[36:39], s75 offen offset:0 nt
    buffer_load_dwordx4 v[78:81], v4, s[36:39], s75 offen offset:1536 nt
    buffer_load_dwordx2 v[82:83], v5, s[36:39], s75 offen offset:1536 nt
    buffer_load_dwordx4 v[84:87], v4, s[36:39], s75 offen offset:3072 nt
    buffer_load_dwordx2 v[88:89], v5, s[36:39], s75 offen offset:3072 nt
    buffer_load_dwordx4 v[90:93], v4, s[36:39], s76 offen offset:0 nt
    buffer_load_dwordx2 v[94:95], v5, s[36:39], s76 offen offset:0 nt
    buffer_load_dwordx4 v[96:99], v4, s[36:39], s76 offen offset:1536 nt
    buffer_load_dwordx2 v[100:101], v5, s[36:39], s76 offen offset:1536 nt
    buffer_load_dwordx4 v[102:105], v4, s[36:39], s76 offen offset:3072 nt
    buffer_load_dwordx2 v[106:107], v5, s[36:39], s76 offen offset:3072 nt
    buffer_load_dwordx4 v[108:111], v4, s[36:39], s77 offen offset:0 nt
    buffer_load_dwordx2 v[112:113], v5, s[36:39], s77 offen offset:0 nt
    buffer_load_dwordx4 v[114:117], v4, s[36:39], s77 offen offset:1536 nt
    buffer_load_dwordx2 v[118:119], v5, s[36:39], s77 offen offset:1536 nt
    s_mov_b32 s80, 0x3d93cd3a
    s_mov_b32 s81, 0x3fb8aa3b
    s_cmp_gt_u32 s64, 3
    s_cbranch_scc1 L_qwait
    s_getreg_b32 s79, hwreg(HW_REG_XCC_ID)
    s_and_b32 s79, s79, 7
    s_xor_b32 s79, s79, s26
    s_mov_b32 s78, 0
    s_lshl_b32 s91, s67, 14
    s_add_u32 s91, s91, 1048576
    s_mul_i32 s74, s64, 24
    v_and_b32 v120, 7, v1
    v_lshlrev_b32 v120, 11, v120
    v_lshrrev_b32 v121, 3, v1
    v_add_u32 v121, s74, v121
    v_lshl_add_u32 v120, v121, 4, v120
    s_mov_b32 s92, 20000
    s_mov_b32 s75, 0
L_qpoll:
    s_nop 4
    s_cmp_eq_u32 s78, 0
    s_cbranch_scc1 L_qpoll_f
    buffer_load_dwordx4 v[6:9], v120, s[60:63], s91 offen offset:0 sc1
    buffer_load_dwordx4 v[10:13], v120, s[60:63], s91 offen offset:128 sc1
    buffer_load_dwordx4 v[14:17], v120, s[60:63], s91 offen offset:256 sc1
    s_branch L_qpoll_w
L_qpoll_f:
    s_nop 4
    buffer_load_dwordx4 v[6:9], v120, s[60:63], s91 offen offset:0 nt
    buffer_load_dwordx4 v[10:13], v120, s[60:63], s91 offen offset:128 nt
    buffer_load_dwordx4 v[14:17], v120, s[60:63], s91 offen offset:256 nt
L_qpoll_w:
    s_nop 4
    s_waitcnt vmcnt(0)
    v_xor_b32 v18, s26, v7
    v_xor_b32 v19, s26, v9
    v_lshrrev_b32 v19, 3, v19
    v_or_b32 v18, v18, v19
    v_cmp_eq_u32 s[86:87], 0, v18
    v_cmp_eq_u32 s[88:89], s79, v9
    s_nop 4
    s_mov_b64 s[94:95], s[86:87]
    s_mov_b64 s[76:77], s[88:89]
    v_xor_b32 v18, s26, v11
    v_xor_b32 v19, s26, v13
    v_lshrrev_b32 v19, 3, v19
    v_or_b32 v18, v18, v19
    v_cmp_eq_u32 s[86:87], 0, v18
    v_cmp_eq_u32 s[88:89], s79, v13
    s_nop 4
    s_and_b64 s[94:95], s[94:95], s[86:87]
    s_and_b64 s[76:77], s[76:77], s[88:89]
    v_xor_b32 v18, s26, v15
    v_xor_b32 v19, s26, v17
    v_lshrrev_b32 v19, 3, v19
    v_or_b32 v18, v18, v19
    v_cmp_eq_u32 s[86:87], 0, v18
    v_cmp_eq_u32 s[88:89], s79, v17
    s_nop 4
    s_and_b64 s[94:95], s[94:95], s[86:87]
    s_and_b64 s[76:77], s[76:77], s[88:89]
    s_cmp_eq_u64 s[94:95], exec
    s_cbranch_scc1 L_qpoll_ok
    s_sub_u32 s92, s92, 1
    s_cbranch_scc1 L_qpoll_ok2
    s_add_u32 s75, s75, 1
    s_cmp_lt_u32 s75, 6
    s_cbranch_scc1 L_qpoll
    s_cmp_eq_u32 s78, 1
    s_cbranch_scc1 L_qpoll
    s_mov_b32 s78, 1
    v_mov_b32 v23, 0
L_qpoll_r1:
    s_nop 4
    ds_read_b32 v22, v23 offset:18636
    s_waitcnt lgkmcnt(0)
    v_readfirstlane_b32 s76, v22
    s_nop 3
    s_cmp_eq_u32 s76, 1
    s_cbranch_scc0 L_qpoll_r1
    v_lshlrev_b32 v22, 4, v1
    ds_read_b128 v[6:9], v22 offset:51008
    ds_read_b128 v[10:13], v22 offset:52032
    ds_read_b128 v[14:17], v22 offset:53056
    ds_read_b128 v[18:21], v22 offset:54080
    v_mov_b32 v23, 0x70000000
    v_cmp_gt_u32 vcc, 32, v1
    s_nop 1
    v_cndmask_b32 v23, v23, v22, vcc
    s_lshl_b32 s89, s69, 11
    s_add_u32 s89, s89, 6291456
    s_waitcnt lgkmcnt(0)
    buffer_store_dwordx4 v[6:9], v22, s[60:63], s85 offen sc1
    buffer_store_dwordx4 v[10:13], v23, s[60:63], s85 offen offset:1024 sc1
    buffer_store_dwordx4 v[14:17], v22, s[60:63], s89 offen sc1
    buffer_store_dwordx4 v[18:21], v23, s[60:63], s89 offen offset:1024 sc1
    s_waitcnt vmcnt(0)
    s_branch L_qpoll
L_qpoll_ok:
    s_nop 4
    s_cmp_eq_u64 s[76:77], exec
    s_cbranch_scc1 L_qpoll_ok2
    s_cmp_eq_u32 s78, 1
    s_cbranch_scc1 L_qpoll_ok2
    s_mov_b32 s78, 1
    v_mov_b32 v23, 0
L_qpoll_r2:
    s_nop 4
    ds_read_b32 v22, v23 offset:18636
    s_waitcnt lgkmcnt(0)
    v_readfirstlane_b32 s76, v22
    s_nop 3
    s_cmp_eq_u32 s76, 1
    s_cbranch_scc0 L_qpoll_r2
    v_lshlrev_b32 v22, 4, v1
    ds_read_b128 v[6:9], v22 offset:51008
    ds_read_b128 v[10:13], v22 offset:52032
    ds_read_b128 v[14:17], v22 offset:53056
    ds_read_b128 v[18:21], v22 offset:54080
    v_mov_b32 v23, 0x70000000
    v_cmp_gt_u32 vcc, 32, v1
    s_nop 1
    v_cndmask_b32 v23, v23, v22, vcc
    s_lshl_b32 s89, s69, 11
    s_add_u32 s89, s89, 6291456
    s_waitcnt lgkmcnt(0)
    buffer_store_dwordx4 v[6:9], v22, s[60:63], s85 offen sc1
    buffer_store_dwordx4 v[10:13], v23, s[60:63], s85 offen offset:1024 sc1
    buffer_store_dwordx4 v[14:17], v22, s[60:63], s89 offen sc1
    buffer_store_dwordx4 v[18:21], v23, s[60:63], s89 offen offset:1024 sc1
    s_waitcnt vmcnt(0)
    s_branch L_qpoll
L_qpoll_ok2:
    s_nop 4
    v_add_f32_dpp v6, v6, v6 quad_perm:[1,0,3,2] row_mask:0xf bank_mask:0xf
    v_add_f32_dpp v8, v8, v8 quad_perm:[1,0,3,2] row_mask:0xf bank_mask:0xf
    v_add_f32_dpp v10, v10, v10 quad_perm:[1,0,3,2] row_mask:0xf bank_mask:0xf
    v_add_f32_dpp v12, v12, v12 quad_perm:[1,0,3,2] row_mask:0xf bank_mask:0xf
    v_add_f32_dpp v14, v14, v14 quad_perm:[1,0,3,2] row_mask:0xf bank_mask:0xf
    v_add_f32_dpp v16, v16, v16 quad_perm:[1,0,3,2] row_mask:0xf bank_mask:0xf
    v_add_f32_dpp v6, v6, v6 quad_perm:[2,3,0,1] row_mask:0xf bank_mask:0xf
    v_add_f32_dpp v8, v8, v8 quad_perm:[2,3,0,1] row_mask:0xf bank_mask:0xf
    v_add_f32_dpp v10, v10, v10 quad_perm:[2,3,0,1] row_mask:0xf bank_mask:0xf
    v_add_f32_dpp v12, v12, v12 quad_perm:[2,3,0,1] row_mask:0xf bank_mask:0xf
    v_add_f32_dpp v14, v14, v14 quad_perm:[2,3,0,1] row_mask:0xf bank_mask:0xf
    v_add_f32_dpp v16, v16, v16 quad_perm:[2,3,0,1] row_mask:0xf bank_mask:0xf
    v_add_f32_dpp v6, v6, v6 row_half_mirror row_mask:0xf bank_mask:0xf
    v_add_f32_dpp v8, v8, v8 row_half_mirror row_mask:0xf bank_mask:0xf
    v_add_f32_dpp v10, v10, v10 row_half_mirror row_mask:0xf bank_mask:0xf
    v_add_f32_dpp v12, v12, v12 row_half_mirror row_mask:0xf bank_mask:0xf
    v_add_f32_dpp v14, v14, v14 row_half_mirror row_mask:0xf bank_mask:0xf
    v_add_f32_dpp v16, v16, v16 row_half_mirror row_mask:0xf bank_mask:0xf
    v_lshlrev_b32 v121, 2, v121
    v_cvt_pk_bf16_f32 v7, v6, v8
    ds_write_b32 v121, v7 offset:17920
    v_cvt_pk_bf16_f32 v11, v10, v12
    ds_write_b32 v121, v11 offset:17952
    v_cvt_pk_bf16_f32 v15, v14, v16
    ds_write_b32 v121, v15 offset:17984
    s_cmp_lg_u32 s64, 0
    s_cbranch_scc1 L_qsig
    s_lshl_b32 s74, s65, 16
    s_add_u32 s74, s74, 6291456
    s_mul_i32 s91, s66, 48
    s_add_u32 s74, s74, s91
    v_and_b32 v10, 31, v1
    v_lshlrev_b32 v10, 11, v10
    v_lshrrev_b32 v9, 5, v1
    v_lshl_add_u32 v120, v9, 4, v10
    v_add_u32 v121, 32, v10
    v_mov_b32 v20, 0x70000000
    v_cmp_le_u32 s[72:73], 32, v1
    s_nop 1
    v_cndmask_b32 v121, v121, v20, s[72:73]
    s_mov_b32 s92, 20000
    s_mov_b32 s75, 0
L_hpoll:
    s_nop 4
    s_cmp_eq_u32 s78, 0
    s_cbranch_scc1 L_hpoll_f
    buffer_load_dwordx4 v[6:9], v120, s[60:63], s74 offen sc1
    buffer_load_dwordx4 v[10:13], v121, s[60:63], s74 offen sc1
    s_branch L_hpoll_w
L_hpoll_f:
    s_nop 4
    buffer_load_dwordx4 v[6:9], v120, s[60:63], s74 offen nt
    buffer_load_dwordx4 v[10:13], v121, s[60:63], s74 offen nt
L_hpoll_w:
    s_nop 4
    s_waitcnt vmcnt(0)
    v_xor_b32 v18, s26, v7
    v_xor_b32 v19, s26, v9
    v_lshrrev_b32 v19, 3, v19
    v_or_b32 v18, v18, v19
    v_cmp_eq_u32 s[86:87], 0, v18
    v_cmp_eq_u32 s[88:89], s79, v9
    s_nop 4
    s_mov_b64 s[94:95], s[86:87]
    s_mov_b64 s[76:77], s[88:89]
    v_xor_b32 v18, s26, v11
    v_xor_b32 v19, s26, v13
    v_lshrrev_b32 v19, 3, v19
    v_or_b32 v18, v18, v19
    v_cmp_eq_u32 s[86:87], 0, v18
    v_cmp_eq_u32 s[88:89], s79, v13
    s_nop 4
    s_or_b64 s[86:87], s[86:87], s[72:73]
    s_or_b64 s[88:89], s[88:89], s[72:73]
    s_and_b64 s[94:95], s[94:95], s[86:87]
    s_and_b64 s[76:77], s[76:77], s[88:89]
    s_cmp_eq_u64 s[94:95], exec
    s_cbranch_scc1 L_hpoll_ok
    s_sub_u32 s92, s92, 1
    s_cbranch_scc1 L_hpoll_ok2
    s_add_u32 s75, s75, 1
    s_cmp_lt_u32 s75, 6
    s_cbranch_scc1 L_hpoll
    s_cmp_eq_u32 s78, 1
    s_cbranch_scc1 L_hpoll
    s_mov_b32 s78, 1
    v_mov_b32 v23, 0
L_hpoll_r1:
    s_nop 4
    ds_read_b32 v22, v23 offset:18636
    s_waitcnt lgkmcnt(0)
    v_readfirstlane_b32 s76, v22
    s_nop 3
    s_cmp_eq_u32 s76, 1
    s_cbranch_scc0 L_hpoll_r1
    v_lshlrev_b32 v22, 4, v1
    ds_read_b128 v[6:9], v22 offset:51008
    ds_read_b128 v[10:13], v22 offset:52032
    ds_read_b128 v[14:17], v22 offset:53056
    ds_read_b128 v[18:21], v22 offset:54080
    v_mov_b32 v23, 0x70000000
    v_cmp_gt_u32 vcc, 32, v1
    s_nop 1
    v_cndmask_b32 v23, v23, v22, vcc
    s_lshl_b32 s89, s69, 11
    s_add_u32 s89, s89, 6291456
    s_waitcnt lgkmcnt(0)
    buffer_store_dwordx4 v[6:9], v22, s[60:63], s85 offen sc1
    buffer_store_dwordx4 v[10:13], v23, s[60:63], s85 offen offset:1024 sc1
    buffer_store_dwordx4 v[14:17], v22, s[60:63], s89 offen sc1
    buffer_store_dwordx4 v[18:21], v23, s[60:63], s89 offen offset:1024 sc1
    s_waitcnt vmcnt(0)
    s_branch L_hpoll
L_hpoll_ok:
    s_nop 4
    s_cmp_eq_u64 s[76:77], exec
    s_cbranch_scc1 L_hpoll_ok2
    s_cmp_eq_u32 s78, 1
    s_cbranch_scc1 L_hpoll_ok2
    s_mov_b32 s78, 1
    v_mov_b32 v23, 0
L_hpoll_r2:
    s_nop 4
    ds_read_b32 v22, v23 offset:18636
    s_waitcnt lgkmcnt(0)
    v_readfirstlane_b32 s76, v22
    s_nop 3
    s_cmp_eq_u32 s76, 1
    s_cbranch_scc0 L_hpoll_r2
    v_lshlrev_b32 v22, 4, v1
    ds_read_b128 v[6:9], v22 offset:51008
    ds_read_b128 v[10:13], v22 offset:52032
    ds_read_b128 v[14:17], v22 offset:53056
    ds_read_b128 v[18:21], v22 offset:54080
    v_mov_b32 v23, 0x70000000
    v_cmp_gt_u32 vcc, 32, v1
    s_nop 1
    v_cndmask_b32 v23, v23, v22, vcc
    s_lshl_b32 s89, s69, 11
    s_add_u32 s89, s89, 6291456
    s_waitcnt lgkmcnt(0)
    buffer_store_dwordx4 v[6:9], v22, s[60:63], s85 offen sc1
    buffer_store_dwordx4 v[10:13], v23, s[60:63], s85 offen offset:1024 sc1
    buffer_store_dwordx4 v[14:17], v22, s[60:63], s89 offen sc1
    buffer_store_dwordx4 v[18:21], v23, s[60:63], s89 offen offset:1024 sc1
    s_waitcnt vmcnt(0)
    s_branch L_hpoll
L_hpoll_ok2:
    s_nop 4
    v_add_f32_dpp v6, v6, v6 quad_perm:[1,0,3,2] row_mask:0xf bank_mask:0xf
    v_add_f32_dpp v8, v8, v8 quad_perm:[1,0,3,2] row_mask:0xf bank_mask:0xf
    v_add_f32_dpp v10, v10, v10 quad_perm:[1,0,3,2] row_mask:0xf bank_mask:0xf
    v_add_f32_dpp v12, v12, v12 quad_perm:[1,0,3,2] row_mask:0xf bank_mask:0xf
    v_add_f32_dpp v6, v6, v6 quad_perm:[2,3,0,1] row_mask:0xf bank_mask:0xf
    v_add_f32_dpp v8, v8, v8 quad_perm:[2,3,0,1] row_mask:0xf bank_mask:0xf
    v_add_f32_dpp v10, v10, v10 quad_perm:[2,3,0,1] row_mask:0xf bank_mask:0xf
    v_add_f32_dpp v12, v12, v12 quad_perm:[2,3,0,1] row_mask:0xf bank_mask:0xf
    v_add_f32_dpp v6, v6, v6 row_half_mirror row_mask:0xf bank_mask:0xf
    v_add_f32_dpp v8, v8, v8 row_half_mirror row_mask:0xf bank_mask:0xf
    v_add_f32_dpp v10, v10, v10 row_half_mirror row_mask:0xf bank_mask:0xf
    v_add_f32_dpp v12, v12, v12 row_half_mirror row_mask:0xf bank_mask:0xf
    v_add_f32_dpp v6, v6, v6 row_mirror row_mask:0xf bank_mask:0xf
    v_add_f32_dpp v8, v8, v8 row_mirror row_mask:0xf bank_mask:0xf
    v_add_f32_dpp v10, v10, v10 row_mirror row_mask:0xf bank_mask:0xf
    v_add_f32_dpp v12, v12, v12 row_mirror row_mask:0xf bank_mask:0xf
    v_mov_b32 v7, v6
    v_mov_b32 v9, v8
    v_mov_b32 v11, v10
    v_mov_b32 v13, v12
    v_permlane16_swap_b32 v6, v7
    v_permlane16_swap_b32 v8, v9
    v_permlane16_swap_b32 v10, v11
    v_permlane16_swap_b32 v12, v13
    v_add_f32 v6, v6, v7
    v_add_f32 v8, v8, v9
    v_add_f32 v10, v10, v11
    v_add_f32 v12, v12, v13
    v_cvt_pk_bf16_f32 v7, v6, v8
    v_lshlrev_b32 v6, 16, v7
    v_and_b32 v8, 0xffff0000, v7
    v_cvt_pk_bf16_f32 v7, v10, v12
    v_lshlrev_b32 v10, 16, v7
    v_and_b32 v12, 0xffff0000, v7
    v_max_f32 v6, 0, v6
    v_max_f32 v8, 0, v8
    v_max_f32 v10, 0, v10
    v_max_f32 v12, 0, v12
    v_mov_b32 v7, v8
    v_mov_b32 v11, v12
    v_lshrrev_b32 v14, 5, v1
    v_lshlrev_b32 v14, 3, v14
    ds_write_b64 v14, v[6:7] offset:18560
    v_mov_b32 v14, 0
    s_mov_b64 exec, 1
    ds_write_b64 v14, v[10:11] offset:18576
    s_mov_b64 exec, -1
L_qsig:
    s_nop 4
    v_mov_b32 v20, 0
    v_mov_b32 v21, 1
    v_mov_b32 v22, s78
    ds_or_b32 v20, v22 offset:18632
    s_waitcnt lgkmcnt(0)
    s_mov_b64 exec, 1
    ds_add_u32 v20, v21 offset:18628
    s_mov_b64 exec, -1
L_qwait:
    s_nop 4
    v_mov_b32 v20, 0
    ds_read_b32 v21, v20 offset:18628
    s_waitcnt lgkmcnt(0)
    v_readfirstlane_b32 s74, v21
    s_nop 3
    s_cmp_ge_u32 s74, 4
    s_cbranch_scc1 L_qready
    s_sleep 2
    s_branch L_qwait
L_qready:
    s_nop 4
    v_lshlrev_b32 v6, 4, v2
    v_lshlrev_b32 v7, 3, v2
    ds_read_b128 v[18:21], v6 offset:17920
    ds_read_b64 v[22:23], v7 offset:18176
    v_mul_u32_u24 v8, 52429, v0
    v_lshrrev_b32 v8, 22, v8
    v_lshlrev_b32 v8, 2, v8
    v_min_u32 v9, 20, v8
    ds_read_b32 v16, v9 offset:18560
    s_waitcnt lgkmcnt(0)
    s_waitcnt vmcnt(16)
    v_lshlrev_b32 v14, 16, v124
    v_and_b32 v15, 0xffff0000, v124
    v_mul_f32 v6, v16, v14
    v_mul_f32 v7, v16, v15
    v_lshlrev_b32 v14, 16, v125
    v_and_b32 v15, 0xffff0000, v125
    v_mul_f32 v8, v16, v14
    v_mul_f32 v9, v16, v15
    v_lshlrev_b32 v14, 16, v126
    v_and_b32 v15, 0xffff0000, v126
    v_mul_f32 v10, v16, v14
    v_mul_f32 v11, v16, v15
    v_lshlrev_b32 v14, 16, v127
    v_and_b32 v15, 0xffff0000, v127
    v_mul_f32 v12, v16, v14
    v_mul_f32 v13, v16, v15
    v_lshlrev_b32 v14, 5, v0
    v_cmp_gt_u32 vcc, 480, v0
    s_and_saveexec_b64 s[86:87], vcc
    ds_write_b128 v14, v[6:9] offset:20288
    ds_write_b128 v14, v[10:13] offset:20304
    s_mov_b64 exec, -1
    v_dot2_f32_bf16 v24, v24, v18, 0
    v_dot2_f32_bf16 v30, v30, v18, 0
    v_dot2_f32_bf16 v36, v36, v18, 0
    v_dot2_f32_bf16 v42, v42, v18, 0
    v_dot2_f32_bf16 v24, v25, v19, v24
    v_dot2_f32_bf16 v30, v31, v19, v30
    v_dot2_f32_bf16 v36, v37, v19, v36
    v_dot2_f32_bf16 v42, v43, v19, v42
    v_dot2_f32_bf16 v24, v26, v20, v24
    v_dot2_f32_bf16 v30, v32, v20, v30
    v_dot2_f32_bf16 v36, v38, v20, v36
    v_dot2_f32_bf16 v42, v44, v20, v42
    v_dot2_f32_bf16 v24, v27, v21, v24
    v_dot2_f32_bf16 v30, v33, v21, v30
    v_dot2_f32_bf16 v36, v39, v21, v36
    v_dot2_f32_bf16 v42, v45, v21, v42
    v_dot2_f32_bf16 v24, v28, v22, v24
    v_dot2_f32_bf16 v30, v34, v22, v30
    v_dot2_f32_bf16 v36, v40, v22, v36
    v_dot2_f32_bf16 v42, v46, v22, v42
    v_dot2_f32_bf16 v24, v29, v23, v24
    v_dot2_f32_bf16 v30, v35, v23, v30
    v_dot2_f32_bf16 v36, v41, v23, v36
    v_dot2_f32_bf16 v42, v47, v23, v42
    v_add_f32_dpp v24, v24, v24 quad_perm:[1,0,3,2] row_mask:0xf bank_mask:0xf
    v_add_f32_dpp v30, v30, v30 quad_perm:[1,0,3,2] row_mask:0xf bank_mask:0xf
    v_add_f32_dpp v36, v36, v36 quad_perm:[1,0,3,2] row_mask:0xf bank_mask:0xf
    v_add_f32_dpp v42, v42, v42 quad_perm:[1,0,3,2] row_mask:0xf bank_mask:0xf
    v_add_f32_dpp v24, v24, v24 quad_perm:[2,3,0,1] row_mask:0xf bank_mask:0xf
    v_add_f32_dpp v30, v30, v30 quad_perm:[2,3,0,1] row_mask:0xf bank_mask:0xf
    v_add_f32_dpp v36, v36, v36 quad_perm:[2,3,0,1] row_mask:0xf bank_mask:0xf
    v_add_f32_dpp v42, v42, v42 quad_perm:[2,3,0,1] row_mask:0xf bank_mask:0xf
    v_add_f32_dpp v24, v24, v24 row_half_mirror row_mask:0xf bank_mask:0xf
    v_add_f32_dpp v30, v30, v30 row_half_mirror row_mask:0xf bank_mask:0xf
    v_add_f32_dpp v36, v36, v36 row_half_mirror row_mask:0xf bank_mask:0xf
    v_add_f32_dpp v42, v42, v42 row_half_mirror row_mask:0xf bank_mask:0xf
    v_add_f32_dpp v24, v24, v24 row_mirror row_mask:0xf bank_mask:0xf
    v_add_f32_dpp v30, v30, v30 row_mirror row_mask:0xf bank_mask:0xf
    v_add_f32_dpp v36, v36, v36 row_mirror row_mask:0xf bank_mask:0xf
    v_add_f32_dpp v42, v42, v42 row_mirror row_mask:0xf bank_mask:0xf
    v_cvt_pk_bf16_f32 v25, v24, v30
    v_lshlrev_b32 v24, 16, v25
    v_and_b32 v30, 0xffff0000, v25
    v_mul_f32 v24, s80, v24
    v_mul_f32 v30, s80, v30
    v_cvt_pk_bf16_f32 v25, v24, v30
    v_lshlrev_b32 v24, 16, v25
    v_and_b32 v30, 0xffff0000, v25
    v_cvt_pk_bf16_f32 v37, v36, v42
    v_lshlrev_b32 v36, 16, v37
    v_and_b32 v42, 0xffff0000, v37
    v_mul_f32 v36, s80, v36
    v_mul_f32 v42, s80, v42
    v_cvt_pk_bf16_f32 v37, v36, v42
    v_lshlrev_b32 v36, 16, v37
    v_and_b32 v42, 0xffff0000, v37
    v_dot2_f32_bf16 v48, v48, v18, 0
    v_dot2_f32_bf16 v54, v54, v18, 0
    v_dot2_f32_bf16 v60, v60, v18, 0
    v_dot2_f32_bf16 v66, v66, v18, 0
    v_dot2_f32_bf16 v48, v49, v19, v48
    v_dot2_f32_bf16 v54, v55, v19, v54
    v_dot2_f32_bf16 v60, v61, v19, v60
    v_dot2_f32_bf16 v66, v67, v19, v66
    v_dot2_f32_bf16 v48, v50, v20, v48
    v_dot2_f32_bf16 v54, v56, v20, v54
    v_dot2_f32_bf16 v60, v62, v20, v60
    v_dot2_f32_bf16 v66, v68, v20, v66
    v_dot2_f32_bf16 v48, v51, v21, v48
    v_dot2_f32_bf16 v54, v57, v21, v54
    v_dot2_f32_bf16 v60, v63, v21, v60
    v_dot2_f32_bf16 v66, v69, v21, v66
    v_dot2_f32_bf16 v48, v52, v22, v48
    v_dot2_f32_bf16 v54, v58, v22, v54
    v_dot2_f32_bf16 v60, v64, v22, v60
    v_dot2_f32_bf16 v66, v70, v22, v66
    v_dot2_f32_bf16 v48, v53, v23, v48
    v_dot2_f32_bf16 v54, v59, v23, v54
    v_dot2_f32_bf16 v60, v65, v23, v60
    v_dot2_f32_bf16 v66, v71, v23, v66
    v_add_f32_dpp v48, v48, v48 quad_perm:[1,0,3,2] row_mask:0xf bank_mask:0xf
    v_add_f32_dpp v54, v54, v54 quad_perm:[1,0,3,2] row_mask:0xf bank_mask:0xf
    v_add_f32_dpp v60, v60, v60 quad_perm:[1,0,3,2] row_mask:0xf bank_mask:0xf
    v_add_f32_dpp v66, v66, v66 quad_perm:[1,0,3,2] row_mask:0xf bank_mask:0xf
    v_add_f32_dpp v48, v48, v48 quad_perm:[2,3,0,1] row_mask:0xf bank_mask:0xf
    v_add_f32_dpp v54, v54, v54 quad_perm:[2,3,0,1] row_mask:0xf bank_mask:0xf
    v_add_f32_dpp v60, v60, v60 quad_perm:[2,3,0,1] row_mask:0xf bank_mask:0xf
    v_add_f32_dpp v66, v66, v66 quad_perm:[2,3,0,1] row_mask:0xf bank_mask:0xf
    v_add_f32_dpp v48, v48, v48 row_half_mirror row_mask:0xf bank_mask:0xf
    v_add_f32_dpp v54, v54, v54 row_half_mirror row_mask:0xf bank_mask:0xf
    v_add_f32_dpp v60, v60, v60 row_half_mirror row_mask:0xf bank_mask:0xf
    v_add_f32_dpp v66, v66, v66 row_half_mirror row_mask:0xf bank_mask:0xf
    v_add_f32_dpp v48, v48, v48 row_mirror row_mask:0xf bank_mask:0xf
    v_add_f32_dpp v54, v54, v54 row_mirror row_mask:0xf bank_mask:0xf
    v_add_f32_dpp v60, v60, v60 row_mirror row_mask:0xf bank_mask:0xf
    v_add_f32_dpp v66, v66, v66 row_mirror row_mask:0xf bank_mask:0xf
    v_cvt_pk_bf16_f32 v49, v48, v54
    v_lshlrev_b32 v48, 16, v49
    v_and_b32 v54, 0xffff0000, v49
    v_mul_f32 v48, s80, v48
    v_mul_f32 v54, s80, v54
    v_cvt_pk_bf16_f32 v49, v48, v54
    v_lshlrev_b32 v48, 16, v49
    v_and_b32 v54, 0xffff0000, v49
    v_cvt_pk_bf16_f32 v61, v60, v66
    v_lshlrev_b32 v60, 16, v61
    v_and_b32 v66, 0xffff0000, v61
    v_mul_f32 v60, s80, v60
    v_mul_f32 v66, s80, v66
    v_cvt_pk_bf16_f32 v61, v60, v66
    v_lshlrev_b32 v60, 16, v61
    v_and_b32 v66, 0xffff0000, v61
    v_max_f32 v40, v24, v30
    v_max_f32 v40, v40, v36
    v_max_f32 v40, v40, v42
    v_max_f32 v40, v40, v48
    v_max_f32 v40, v40, v54
    v_max_f32 v40, v40, v60
    v_max_f32 v40, v40, v66
    v_mov_b32 v41, v40
    s_nop 1
    v_permlane16_swap_b32 v40, v41
    v_max_f32 v40, v40, v41
    v_mov_b32 v41, v40
    s_nop 1
    v_permlane32_swap_b32 v40, v41
    v_max_f32 v40, v40, v41
    v_sub_f32 v24, v24, v40
    v_sub_f32 v30, v30, v40
    v_sub_f32 v36, v36, v40
    v_sub_f32 v42, v42, v40
    v_sub_f32 v48, v48, v40
    v_sub_f32 v54, v54, v40
    v_sub_f32 v60, v60, v40
    v_sub_f32 v66, v66, v40
    v_mul_f32 v24, s81, v24
    v_mul_f32 v30, s81, v30
    v_mul_f32 v36, s81, v36
    v_mul_f32 v42, s81, v42
    v_mul_f32 v48, s81, v48
    v_mul_f32 v54, s81, v54
    v_mul_f32 v60, s81, v60
    v_mul_f32 v66, s81, v66
    v_exp_f32 v24, v24
    v_exp_f32 v30, v30
    v_exp_f32 v36, v36
    v_exp_f32 v42, v42
    v_exp_f32 v48, v48
    v_exp_f32 v54, v54
    v_exp_f32 v60, v60
    v_exp_f32 v66, v66
    v_add_f32 v41, v24, v30
    v_add_f32 v41, v41, v36
    v_add_f32 v41, v41, v42
    v_add_f32 v41, v41, v48
    v_add_f32 v41, v41, v54
    v_add_f32 v41, v41, v60
    v_add_f32 v41, v41, v66
    v_mov_b32 v45, v41
    s_nop 1
    v_permlane16_swap_b32 v41, v45
    v_add_f32 v41, v41, v45
    v_mov_b32 v45, v41
    s_nop 1
    v_permlane32_swap_b32 v41, v45
    v_add_f32 v41, v41, v45
    s_lshl_b32 s74, s64, 2
    v_mov_b32 v43, s74
    ds_write_b32 v43, v40 offset:18304
    ds_write_b32 v43, v41 offset:18368
    s_waitcnt vmcnt(14)
    v_lshlrev_b32 v45, 16, v72
    v_and_b32 v46, 0xffff0000, v72
    v_mul_f32 v6, v24, v45
    v_mul_f32 v7, v24, v46
    v_lshlrev_b32 v45, 16, v73
    v_and_b32 v46, 0xffff0000, v73
    v_mul_f32 v8, v24, v45
    v_mul_f32 v9, v24, v46
    v_lshlrev_b32 v45, 16, v74
    v_and_b32 v46, 0xffff0000, v74
    v_mul_f32 v10, v24, v45
    v_mul_f32 v11, v24, v46
    v_lshlrev_b32 v45, 16, v75
    v_and_b32 v46, 0xffff0000, v75
    v_mul_f32 v12, v24, v45
    v_mul_f32 v13, v24, v46
    v_lshlrev_b32 v45, 16, v76
    v_and_b32 v46, 0xffff0000, v76
    v_mul_f32 v14, v24, v45
    v_mul_f32 v15, v24, v46
    v_lshlrev_b32 v45, 16, v77
    v_and_b32 v46, 0xffff0000, v77
    v_mul_f32 v16, v24, v45
    v_mul_f32 v17, v24, v46
    s_waitcnt vmcnt(12)
    v_lshlrev_b32 v45, 16, v78
    v_and_b32 v46, 0xffff0000, v78
    v_fmac_f32 v6, v30, v45
    v_fmac_f32 v7, v30, v46
    v_lshlrev_b32 v45, 16, v79
    v_and_b32 v46, 0xffff0000, v79
    v_fmac_f32 v8, v30, v45
    v_fmac_f32 v9, v30, v46
    v_lshlrev_b32 v45, 16, v80
    v_and_b32 v46, 0xffff0000, v80
    v_fmac_f32 v10, v30, v45
    v_fmac_f32 v11, v30, v46
    v_lshlrev_b32 v45, 16, v81
    v_and_b32 v46, 0xffff0000, v81
    v_fmac_f32 v12, v30, v45
    v_fmac_f32 v13, v30, v46
    v_lshlrev_b32 v45, 16, v82
    v_and_b32 v46, 0xffff0000, v82
    v_fmac_f32 v14, v30, v45
    v_fmac_f32 v15, v30, v46
    v_lshlrev_b32 v45, 16, v83
    v_and_b32 v46, 0xffff0000, v83
    v_fmac_f32 v16, v30, v45
    v_fmac_f32 v17, v30, v46
    s_waitcnt vmcnt(10)
    v_lshlrev_b32 v45, 16, v84
    v_and_b32 v46, 0xffff0000, v84
    v_fmac_f32 v6, v36, v45
    v_fmac_f32 v7, v36, v46
    v_lshlrev_b32 v45, 16, v85
    v_and_b32 v46, 0xffff0000, v85
    v_fmac_f32 v8, v36, v45
    v_fmac_f32 v9, v36, v46
    v_lshlrev_b32 v45, 16, v86
    v_and_b32 v46, 0xffff0000, v86
    v_fmac_f32 v10, v36, v45
    v_fmac_f32 v11, v36, v46
    v_lshlrev_b32 v45, 16, v87
    v_and_b32 v46, 0xffff0000, v87
    v_fmac_f32 v12, v36, v45
    v_fmac_f32 v13, v36, v46
    v_lshlrev_b32 v45, 16, v88
    v_and_b32 v46, 0xffff0000, v88
    v_fmac_f32 v14, v36, v45
    v_fmac_f32 v15, v36, v46
    v_lshlrev_b32 v45, 16, v89
    v_and_b32 v46, 0xffff0000, v89
    v_fmac_f32 v16, v36, v45
    v_fmac_f32 v17, v36, v46
    s_waitcnt vmcnt(8)
    v_lshlrev_b32 v45, 16, v90
    v_and_b32 v46, 0xffff0000, v90
    v_fmac_f32 v6, v42, v45
    v_fmac_f32 v7, v42, v46
    v_lshlrev_b32 v45, 16, v91
    v_and_b32 v46, 0xffff0000, v91
    v_fmac_f32 v8, v42, v45
    v_fmac_f32 v9, v42, v46
    v_lshlrev_b32 v45, 16, v92
    v_and_b32 v46, 0xffff0000, v92
    v_fmac_f32 v10, v42, v45
    v_fmac_f32 v11, v42, v46
    v_lshlrev_b32 v45, 16, v93
    v_and_b32 v46, 0xffff0000, v93
    v_fmac_f32 v12, v42, v45
    v_fmac_f32 v13, v42, v46
    v_lshlrev_b32 v45, 16, v94
    v_and_b32 v46, 0xffff0000, v94
    v_fmac_f32 v14, v42, v45
    v_fmac_f32 v15, v42, v46
    v_lshlrev_b32 v45, 16, v95
    v_and_b32 v46, 0xffff0000, v95
    v_fmac_f32 v16, v42, v45
    v_fmac_f32 v17, v42, v46
    s_waitcnt vmcnt(6)
    v_lshlrev_b32 v45, 16, v96
    v_and_b32 v46, 0xffff0000, v96
    v_fmac_f32 v6, v48, v45
    v_fmac_f32 v7, v48, v46
    v_lshlrev_b32 v45, 16, v97
    v_and_b32 v46, 0xffff0000, v97
    v_fmac_f32 v8, v48, v45
    v_fmac_f32 v9, v48, v46
    v_lshlrev_b32 v45, 16, v98
    v_and_b32 v46, 0xffff0000, v98
    v_fmac_f32 v10, v48, v45
    v_fmac_f32 v11, v48, v46
    v_lshlrev_b32 v45, 16, v99
    v_and_b32 v46, 0xffff0000, v99
    v_fmac_f32 v12, v48, v45
    v_fmac_f32 v13, v48, v46
    v_lshlrev_b32 v45, 16, v100
    v_and_b32 v46, 0xffff0000, v100
    v_fmac_f32 v14, v48, v45
    v_fmac_f32 v15, v48, v46
    v_lshlrev_b32 v45, 16, v101
    v_and_b32 v46, 0xffff0000, v101
    v_fmac_f32 v16, v48, v45
    v_fmac_f32 v17, v48, v46
    s_waitcnt vmcnt(4)
    v_lshlrev_b32 v45, 16, v102
    v_and_b32 v46, 0xffff0000, v102
    v_fmac_f32 v6, v54, v45
    v_fmac_f32 v7, v54, v46
    v_lshlrev_b32 v45, 16, v103
    v_and_b32 v46, 0xffff0000, v103
    v_fmac_f32 v8, v54, v45
    v_fmac_f32 v9, v54, v46
    v_lshlrev_b32 v45, 16, v104
    v_and_b32 v46, 0xffff0000, v104
    v_fmac_f32 v10, v54, v45
    v_fmac_f32 v11, v54, v46
    v_lshlrev_b32 v45, 16, v105
    v_and_b32 v46, 0xffff0000, v105
    v_fmac_f32 v12, v54, v45
    v_fmac_f32 v13, v54, v46
    v_lshlrev_b32 v45, 16, v106
    v_and_b32 v46, 0xffff0000, v106
    v_fmac_f32 v14, v54, v45
    v_fmac_f32 v15, v54, v46
    v_lshlrev_b32 v45, 16, v107
    v_and_b32 v46, 0xffff0000, v107
    v_fmac_f32 v16, v54, v45
    v_fmac_f32 v17, v54, v46
    s_waitcnt vmcnt(2)
    v_lshlrev_b32 v45, 16, v108
    v_and_b32 v46, 0xffff0000, v108
    v_fmac_f32 v6, v60, v45
    v_fmac_f32 v7, v60, v46
    v_lshlrev_b32 v45, 16, v109
    v_and_b32 v46, 0xffff0000, v109
    v_fmac_f32 v8, v60, v45
    v_fmac_f32 v9, v60, v46
    v_lshlrev_b32 v45, 16, v110
    v_and_b32 v46, 0xffff0000, v110
    v_fmac_f32 v10, v60, v45
    v_fmac_f32 v11, v60, v46
    v_lshlrev_b32 v45, 16, v111
    v_and_b32 v46, 0xffff0000, v111
    v_fmac_f32 v12, v60, v45
    v_fmac_f32 v13, v60, v46
    v_lshlrev_b32 v45, 16, v112
    v_and_b32 v46, 0xffff0000, v112
    v_fmac_f32 v14, v60, v45
    v_fmac_f32 v15, v60, v46
    v_lshlrev_b32 v45, 16, v113
    v_and_b32 v46, 0xffff0000, v113
    v_fmac_f32 v16, v60, v45
    v_fmac_f32 v17, v60, v46
    s_waitcnt vmcnt(0)
    v_lshlrev_b32 v45, 16, v114
    v_and_b32 v46, 0xffff0000, v114
    v_fmac_f32 v6, v66, v45
    v_fmac_f32 v7, v66, v46
    v_lshlrev_b32 v45, 16, v115
    v_and_b32 v46, 0xffff0000, v115
    v_fmac_f32 v8, v66, v45
    v_fmac_f32 v9, v66, v46
    v_lshlrev_b32 v45, 16, v116
    v_and_b32 v46, 0xffff0000, v116
    v_fmac_f32 v10, v66, v45
    v_fmac_f32 v11, v66, v46
    v_lshlrev_b32 v45, 16, v117
    v_and_b32 v46, 0xffff0000, v117
    v_fmac_f32 v12, v66, v45
    v_fmac_f32 v13, v66, v46
    v_lshlrev_b32 v45, 16, v118
    v_and_b32 v46, 0xffff0000, v118
    v_fmac_f32 v14, v66, v45
    v_fmac_f32 v15, v66, v46
    v_lshlrev_b32 v45, 16, v119
    v_and_b32 v46, 0xffff0000, v119
    v_fmac_f32 v16, v66, v45
    v_fmac_f32 v17, v66, v46
    v_permlane32_swap_b32 v6, v7
    v_permlane32_swap_b32 v8, v9
    v_permlane32_swap_b32 v10, v11
    v_permlane32_swap_b32 v12, v13
    v_permlane32_swap_b32 v14, v15
    v_permlane32_swap_b32 v16, v17
    v_add_f32 v6, v6, v7
    v_add_f32 v8, v8, v9
    v_add_f32 v10, v10, v11
    v_add_f32 v12, v12, v13
    v_add_f32 v14, v14, v15
    v_add_f32 v16, v16, v17
    v_permlane16_swap_b32 v6, v8
    v_permlane16_swap_b32 v10, v12
    v_permlane16_swap_b32 v14, v16
    v_add_f32 v6, v6, v8
    v_add_f32 v10, v10, v12
    v_add_f32 v14, v14, v16
    v_and_b32 v18, 1, v3
    v_lshlrev_b32 v18, 1, v18
    v_lshrrev_b32 v19, 1, v3
    v_or_b32 v18, v18, v19
    v_lshlrev_b32 v18, 2, v18
    s_mul_i32 s74, s64, 768
    v_add_u32 v18, s74, v18
    v_lshl_add_u32 v19, v2, 4, v18
    v_lshl_add_u32 v18, v2, 5, v18
    ds_write_b32 v18, v6 offset:2560
    ds_write_b32 v18, v10 offset:2576
    ds_write_b32 v19, v14 offset:3072
    s_waitcnt lgkmcnt(0)
    s_barrier
    v_mov_b32 v64, 0
    ds_read_b32 v64, v64 offset:18632
    s_waitcnt lgkmcnt(0)
    v_readfirstlane_b32 s78, v64
    s_nop 3
    s_cmp_gt_u32 s64, 1
    s_cbranch_scc1 L_pub_b
    v_mov_b32 v64, 0
    ds_read_b128 v[100:103], v64 offset:18304
    ds_read_b128 v[104:107], v64 offset:18320
    ds_read_b128 v[108:111], v64 offset:18336
    ds_read_b128 v[112:115], v64 offset:18352
    v_lshlrev_b32 v65, 3, v0
    v_min_u32 v65, 760, v65
    ds_read_b64 v[68:69], v65 offset:2560
    ds_read_b64 v[70:71], v65 offset:3328
    ds_read_b64 v[72:73], v65 offset:4096
    ds_read_b64 v[74:75], v65 offset:4864
    ds_read_b64 v[76:77], v65 offset:5632
    ds_read_b64 v[78:79], v65 offset:6400
    ds_read_b64 v[80:81], v65 offset:7168
    ds_read_b64 v[82:83], v65 offset:7936
    ds_read_b64 v[84:85], v65 offset:8704
    ds_read_b64 v[86:87], v65 offset:9472
    ds_read_b64 v[88:89], v65 offset:10240
    ds_read_b64 v[90:91], v65 offset:11008
    ds_read_b64 v[92:93], v65 offset:11776
    ds_read_b64 v[94:95], v65 offset:12544
    ds_read_b64 v[96:97], v65 offset:13312
    ds_read_b64 v[98:99], v65 offset:14080
    ds_read_b128 v[6:9], v64 offset:18368
    ds_read_b128 v[10:13], v64 offset:18384
    ds_read_b128 v[14:17], v64 offset:18400
    ds_read_b128 v[18:21], v64 offset:18416
    ds_read_b32 v22, v64 offset:18632
    s_waitcnt lgkmcnt(0)
    v_max_f32 v66, v100, v101
    v_max3_f32 v66, v66, v102, v103
    v_max3_f32 v66, v66, v104, v105
    v_max3_f32 v66, v66, v106, v107
    v_max3_f32 v66, v66, v108, v109
    v_max3_f32 v66, v66, v110, v111
    v_max3_f32 v66, v66, v112, v113
    v_max3_f32 v66, v66, v114, v115
    v_sub_f32 v100, v100, v66
    v_sub_f32 v101, v101, v66
    v_sub_f32 v102, v102, v66
    v_sub_f32 v103, v103, v66
    v_sub_f32 v104, v104, v66
    v_sub_f32 v105, v105, v66
    v_sub_f32 v106, v106, v66
    v_sub_f32 v107, v107, v66
    v_sub_f32 v108, v108, v66
    v_sub_f32 v109, v109, v66
    v_sub_f32 v110, v110, v66
    v_sub_f32 v111, v111, v66
    v_sub_f32 v112, v112, v66
    v_sub_f32 v113, v113, v66
    v_sub_f32 v114, v114, v66
    v_sub_f32 v115, v115, v66
    v_mul_f32 v100, s81, v100
    v_mul_f32 v101, s81, v101
    v_mul_f32 v102, s81, v102
    v_mul_f32 v103, s81, v103
    v_mul_f32 v104, s81, v104
    v_mul_f32 v105, s81, v105
    v_mul_f32 v106, s81, v106
    v_mul_f32 v107, s81, v107
    v_mul_f32 v108, s81, v108
    v_mul_f32 v109, s81, v109
    v_mul_f32 v110, s81, v110
    v_mul_f32 v111, s81, v111
    v_mul_f32 v112, s81, v112
    v_mul_f32 v113, s81, v113
    v_mul_f32 v114, s81, v114
    v_mul_f32 v115, s81, v115
    v_exp_f32 v100, v100
    v_exp_f32 v101, v101
    v_exp_f32 v102, v102
    v_exp_f32 v103, v103
    v_exp_f32 v104, v104
    v_exp_f32 v105, v105
    v_exp_f32 v106, v106
    v_exp_f32 v107, v107
    v_exp_f32 v108, v108
    v_exp_f32 v109, v109
    v_exp_f32 v110, v110
    v_exp_f32 v111, v111
    v_exp_f32 v112, v112
    v_exp_f32 v113, v113
    v_exp_f32 v114, v114
    v_exp_f32 v115, v115
    v_mul_f32 v116, v68, v100
    v_mul_f32 v118, v69, v100
    v_mul_f32 v67, v6, v100
    v_fmac_f32 v116, v70, v101
    v_fmac_f32 v118, v71, v101
    v_fmac_f32 v67, v7, v101
    v_fmac_f32 v116, v72, v102
    v_fmac_f32 v118, v73, v102
    v_fmac_f32 v67, v8, v102
    v_fmac_f32 v116, v74, v103
    v_fmac_f32 v118, v75, v103
    v_fmac_f32 v67, v9, v103
    v_fmac_f32 v116, v76, v104
    v_fmac_f32 v118, v77, v104
    v_fmac_f32 v67, v10, v104
    v_fmac_f32 v116, v78, v105
    v_fmac_f32 v118, v79, v105
    v_fmac_f32 v67, v11, v105
    v_fmac_f32 v116, v80, v106
    v_fmac_f32 v118, v81, v106
    v_fmac_f32 v67, v12, v106
    v_fmac_f32 v116, v82, v107
    v_fmac_f32 v118, v83, v107
    v_fmac_f32 v67, v13, v107
    v_fmac_f32 v116, v84, v108
    v_fmac_f32 v118, v85, v108
    v_fmac_f32 v67, v14, v108
    v_fmac_f32 v116, v86, v109
    v_fmac_f32 v118, v87, v109
    v_fmac_f32 v67, v15, v109
    v_fmac_f32 v116, v88, v110
    v_fmac_f32 v118, v89, v110
    v_fmac_f32 v67, v16, v110
    v_fmac_f32 v116, v90, v111
    v_fmac_f32 v118, v91, v111
    v_fmac_f32 v67, v17, v111
    v_fmac_f32 v116, v92, v112
    v_fmac_f32 v118, v93, v112
    v_fmac_f32 v67, v18, v112
    v_fmac_f32 v116, v94, v113
    v_fmac_f32 v118, v95, v113
    v_fmac_f32 v67, v19, v113
    v_fmac_f32 v116, v96, v114
    v_fmac_f32 v118, v97, v114
    v_fmac_f32 v67, v20, v114
    v_fmac_f32 v116, v98, v115
    v_fmac_f32 v118, v99, v115
    v_fmac_f32 v67, v21, v115
    v_mov_b32 v117, s26
    v_mov_b32 v119, s26
    v_cmp_eq_u32 vcc, 96, v0
    s_nop 1
    v_cndmask_b32 v116, v116, v66, vcc
    v_cndmask_b32 v118, v118, v67, vcc
    v_lshlrev_b32 v64, 4, v0
    v_mov_b32 v65, 0x70000000
    v_cmp_gt_u32 vcc, 97, v0
    s_nop 1
    v_cndmask_b32 v64, v65, v64, vcc
    s_add_u32 s74, s82, 1048576
    s_cmp_eq_u32 s78, 0
    s_cbranch_scc1 L_ppub_fast
    buffer_store_dwordx4 v[116:119], v64, s[60:63], s82 offen sc1
    s_branch L_ppub_done
L_ppub_fast:
    s_nop 4
    buffer_store_dwordx4 v[116:119], v64, s[60:63], s82 offen
L_ppub_done:
    s_nop 4
    v_lshlrev_b32 v65, 4, v0
    v_min_u32 v65, 1584, v65
    ds_write_b128 v65, v[116:119] offset:18688
    s_waitcnt lgkmcnt(0)
    s_branch L_pub_done
L_pub_b:
    s_nop 4
    s_cmp_eq_u32 s64, 2
    s_cbranch_scc1 L_gather
    s_cmp_lt_u32 s64, 4
    s_cbranch_scc1 L_pub_done
    s_cmp_gt_u32 s64, 8
    s_cbranch_scc1 L_pub_done
    v_subrev_u32 v66, 256, v0
    v_lshlrev_b32 v64, 3, v66
    ds_read_b64 v[68:69], v64 offset:20288
    ds_read_b64 v[70:71], v64 offset:22848
    ds_read_b64 v[72:73], v64 offset:25408
    ds_read_b64 v[74:75], v64 offset:27968
    ds_read_b64 v[76:77], v64 offset:30528
    ds_read_b64 v[78:79], v64 offset:33088
    s_waitcnt lgkmcnt(0)
    v_add_f32 v68, v68, v70
    v_add_f32 v72, v72, v74
    v_add_f32 v76, v76, v78
    v_add_f32 v68, v68, v72
    v_add_f32 v69, v69, v71
    v_add_f32 v73, v73, v75
    v_add_f32 v77, v77, v79
    v_add_f32 v69, v69, v73
    v_add_f32 v70, v69, v77
    v_add_f32 v68, v68, v76
    v_mov_b32 v69, s26
    v_mov_b32 v71, s26
    v_lshrrev_b32 v64, 3, v66
    v_and_b32 v65, 7, v66
    v_lshlrev_b32 v64, 12, v64
    v_lshl_add_u32 v64, v65, 4, v64
    s_cmp_eq_u32 s78, 0
    s_cbranch_scc1 L_stb_f
    buffer_store_dwordx4 v[68:71], v64, s[60:63], s84 offen sc1
    s_branch L_stb_g
L_stb_f:
    s_nop 4
    buffer_store_dwordx4 v[68:71], v64, s[60:63], s84 offen
L_stb_g:
    s_nop 4
L_pub_done:
    s_nop 4
    s_barrier
    s_branch L_g_done
L_gather:
    s_nop 4
    s_lshl_b32 s91, s67, 14
    s_add_u32 s91, s91, 524288
    s_add_u32 s90, s91, 1048576
    s_mul_i32 s93, s68, 192
    v_and_b32 v84, 7, v1
    v_lshlrev_b32 v64, 11, v84
    v_lshrrev_b32 v65, 3, v1
    v_lshlrev_b32 v85, 4, v65
    v_add_u32 v85, s93, v85
    v_add_u32 v66, v85, v64
    v_add_u32 v67, 128, v66
    v_mov_b32 v82, 0x70000000
    v_cmp_eq_u32 s[72:73], s68, v84
    v_cmp_le_u32 s[70:71], 32, v1
    s_nop 1
    s_or_b64 s[70:71], s[70:71], s[72:73]
    v_cndmask_b32 v66, v66, v82, s[72:73]
    v_cndmask_b32 v64, v64, v82, s[72:73]
    v_cndmask_b32 v67, v67, v82, s[70:71]
    s_waitcnt vmcnt(0)
    s_mov_b32 s92, 20000
    s_mov_b32 s79, 1
L_gpoll:
    s_nop 4
    s_cmp_eq_u32 s78, 0
    s_cbranch_scc1 L_gpf
    buffer_load_dwordx4 v[68:71], v66, s[60:63], s91 offen sc1
    buffer_load_dwordx4 v[72:75], v67, s[60:63], s91 offen sc1
    buffer_load_dwordx4 v[76:79], v64, s[60:63], s91 offen offset:1536 sc1
    s_branch L_gpg
L_gpf:
    s_nop 4
    buffer_load_dwordx4 v[68:71], v66, s[60:63], s91 offen nt
    buffer_load_dwordx4 v[72:75], v67, s[60:63], s91 offen nt
    buffer_load_dwordx4 v[76:79], v64, s[60:63], s91 offen offset:1536 nt
L_gpg:
    s_nop 4
    s_cmp_eq_u32 s79, 0
    s_cbranch_scc1 L_gp1
    s_mov_b32 s79, 0
    s_barrier
    v_mov_b32 v83, 0
    ds_read_b128 v[100:103], v85 offset:18688
    ds_read_b128 v[104:107], v85 offset:18816
    ds_read_b128 v[108:111], v83 offset:20224
L_gp1:
    s_nop 4
    s_waitcnt vmcnt(0)
    v_xor_b32 v80, s26, v69
    v_xor_b32 v81, s26, v71
    v_or_b32 v80, v80, v81
    v_xor_b32 v81, s26, v77
    v_or_b32 v80, v80, v81
    v_xor_b32 v81, s26, v79
    v_or_b32 v80, v80, v81
    v_cmp_eq_u32 s[94:95], 0, v80
    v_xor_b32 v80, s26, v73
    v_xor_b32 v81, s26, v75
    v_or_b32 v80, v80, v81
    v_cmp_eq_u32 s[86:87], 0, v80
    s_nop 4
    s_or_b64 s[94:95], s[94:95], s[72:73]
    s_or_b64 s[86:87], s[86:87], s[70:71]
    s_and_b64 s[94:95], s[94:95], s[86:87]
    s_nop 4
    s_cmp_eq_u64 s[94:95], exec
    s_cbranch_scc1 L_gpoll_ok
    s_sub_u32 s92, s92, 1
    s_cbranch_scc1 L_gpoll_ok
    s_branch L_gpoll
L_gpoll_ok:
    s_nop 4
    s_waitcnt lgkmcnt(0)
    v_cndmask_b32 v68, v68, v100, s[72:73]
    v_cndmask_b32 v70, v70, v102, s[72:73]
    v_cndmask_b32 v72, v72, v104, s[72:73]
    v_cndmask_b32 v74, v74, v106, s[72:73]
    v_cndmask_b32 v76, v76, v108, s[72:73]
    v_cndmask_b32 v78, v78, v110, s[72:73]
    v_mov_b32 v80, v76
    s_nop 1
    v_max_f32_dpp v80, v80, v80 quad_perm:[1,0,3,2] row_mask:0xf bank_mask:0xf
    s_nop 1
    v_max_f32_dpp v80, v80, v80 quad_perm:[2,3,0,1] row_mask:0xf bank_mask:0xf
    s_nop 1
    v_max_f32_dpp v80, v80, v80 row_half_mirror row_mask:0xf bank_mask:0xf
    v_sub_f32 v80, v76, v80
    v_mul_f32 v80, s81, v80
    v_exp_f32 v80, v80
    s_nop 0
    v_mul_f32 v78, v78, v80
    v_mul_f32 v68, v68, v80
    v_mul_f32 v70, v70, v80
    v_mul_f32 v72, v72, v80
    v_mul_f32 v74, v74, v80
    v_add_f32_dpp v78, v78, v78 quad_perm:[1,0,3,2] row_mask:0xf bank_mask:0xf
    v_add_f32_dpp v68, v68, v68 quad_perm:[1,0,3,2] row_mask:0xf bank_mask:0xf
    v_add_f32_dpp v70, v70, v70 quad_perm:[1,0,3,2] row_mask:0xf bank_mask:0xf
    v_add_f32_dpp v72, v72, v72 quad_perm:[1,0,3,2] row_mask:0xf bank_mask:0xf
    v_add_f32_dpp v74, v74, v74 quad_perm:[1,0,3,2] row_mask:0xf bank_mask:0xf
    v_add_f32_dpp v78, v78, v78 quad_perm:[2,3,0,1] row_mask:0xf bank_mask:0xf
    v_add_f32_dpp v68, v68, v68 quad_perm:[2,3,0,1] row_mask:0xf bank_mask:0xf
    v_add_f32_dpp v70, v70, v70 quad_perm:[2,3,0,1] row_mask:0xf bank_mask:0xf
    v_add_f32_dpp v72, v72, v72 quad_perm:[2,3,0,1] row_mask:0xf bank_mask:0xf
    v_add_f32_dpp v74, v74, v74 quad_perm:[2,3,0,1] row_mask:0xf bank_mask:0xf
    v_add_f32_dpp v78, v78, v78 row_half_mirror row_mask:0xf bank_mask:0xf
    v_add_f32_dpp v68, v68, v68 row_half_mirror row_mask:0xf bank_mask:0xf
    v_add_f32_dpp v70, v70, v70 row_half_mirror row_mask:0xf bank_mask:0xf
    v_add_f32_dpp v72, v72, v72 row_half_mirror row_mask:0xf bank_mask:0xf
    v_add_f32_dpp v74, v74, v74 row_half_mirror row_mask:0xf bank_mask:0xf
    v_rcp_f32 v81, v78
    s_nop 0
    v_mul_f32 v69, v68, v81
    v_fma_f32 v68, -v69, v78, v68
    v_fma_f32 v68, v68, v81, v69
    v_mul_f32 v71, v70, v81
    v_fma_f32 v70, -v71, v78, v70
    v_fma_f32 v70, v70, v81, v71
    v_mul_f32 v73, v72, v81
    v_fma_f32 v72, -v73, v78, v72
    v_fma_f32 v72, v72, v81, v73
    v_mul_f32 v75, v74, v81
    v_fma_f32 v74, -v75, v78, v74
    v_fma_f32 v74, v74, v81, v75
    v_cvt_pk_bf16_f32 v69, v68, v70
    v_lshlrev_b32 v68, 16, v69
    v_and_b32 v70, 0xffff0000, v69
    v_cvt_pk_bf16_f32 v73, v72, v74
    v_lshlrev_b32 v72, 16, v73
    v_and_b32 v74, 0xffff0000, v73
    v_mov_b32 v69, v70
    v_mov_b32 v73, v74
    v_lshlrev_b32 v65, 3, v65
    ds_write_b64 v65, v[68:69] offset:18432
    ds_write_b64 v65, v[72:73] offset:18496
L_g_done:
    s_nop 4
    s_waitcnt lgkmcnt(0)
    s_barrier
    v_mul_u32_u24 v8, 52429, v0
    v_lshrrev_b32 v8, 22, v8
    v_lshlrev_b32 v8, 2, v8
    v_min_u32 v8, 44, v8
    ds_read_b32 v16, v8 offset:18432
    ds_read_b32 v17, v8 offset:18480
    v_lshlrev_b32 v9, 4, v0
    v_min_u32 v9, 15344, v9
    v_add_u32 v9, 55104, v9
    ds_read_b128 v[24:27], v9
    ds_read_b128 v[28:31], v9 offset:15360
    s_waitcnt vmcnt(0) lgkmcnt(0)
    v_lshlrev_b32 v14, 16, v24
    v_and_b32 v15, 0xffff0000, v24
    v_mul_f32 v6, v16, v14
    v_mul_f32 v7, v16, v15
    v_lshlrev_b32 v14, 16, v25
    v_and_b32 v15, 0xffff0000, v25
    v_mul_f32 v8, v16, v14
    v_mul_f32 v9, v16, v15
    v_lshlrev_b32 v14, 16, v26
    v_and_b32 v15, 0xffff0000, v26
    v_mul_f32 v10, v16, v14
    v_mul_f32 v11, v16, v15
    v_lshlrev_b32 v14, 16, v27
    v_and_b32 v15, 0xffff0000, v27
    v_mul_f32 v12, v16, v14
    v_mul_f32 v13, v16, v15
    v_lshlrev_b32 v14, 16, v28
    v_and_b32 v15, 0xffff0000, v28
    v_fmac_f32 v6, v17, v14
    v_fmac_f32 v7, v17, v15
    v_lshlrev_b32 v14, 16, v29
    v_and_b32 v15, 0xffff0000, v29
    v_fmac_f32 v8, v17, v14
    v_fmac_f32 v9, v17, v15
    v_lshlrev_b32 v14, 16, v30
    v_and_b32 v15, 0xffff0000, v30
    v_fmac_f32 v10, v17, v14
    v_fmac_f32 v11, v17, v15
    v_lshlrev_b32 v14, 16, v31
    v_and_b32 v15, 0xffff0000, v31
    v_fmac_f32 v12, v17, v14
    v_fmac_f32 v13, v17, v15
    v_lshlrev_b32 v14, 5, v0
    v_cmp_gt_u32 vcc, 960, v0
    s_and_saveexec_b64 s[86:87], vcc
    ds_write_b128 v14, v[6:9] offset:20288
    ds_write_b128 v14, v[10:13] offset:20304
    s_mov_b64 exec, -1
    s_waitcnt lgkmcnt(0)
    s_barrier
    s_cmp_gt_u32 s64, 4
    s_cbranch_scc1 L_y_done
    v_lshlrev_b32 v14, 3, v0
    ds_read_b64 v[18:19], v14 offset:20288
    ds_read_b64 v[20:21], v14 offset:22848
    ds_read_b64 v[22:23], v14 offset:25408
    ds_read_b64 v[24:25], v14 offset:27968
    ds_read_b64 v[26:27], v14 offset:30528
    ds_read_b64 v[28:29], v14 offset:33088
    ds_read_b64 v[30:31], v14 offset:35648
    ds_read_b64 v[32:33], v14 offset:38208
    ds_read_b64 v[34:35], v14 offset:40768
    ds_read_b64 v[36:37], v14 offset:43328
    ds_read_b64 v[38:39], v14 offset:45888
    ds_read_b64 v[40:41], v14 offset:48448
    s_waitcnt lgkmcnt(0)
    v_add_f32 v18, v18, v20
    v_add_f32 v19, v19, v21
    v_add_f32 v22, v22, v24
    v_add_f32 v23, v23, v25
    v_add_f32 v26, v26, v28
    v_add_f32 v27, v27, v29
    v_add_f32 v30, v30, v32
    v_add_f32 v31, v31, v33
    v_add_f32 v34, v34, v36
    v_add_f32 v35, v35, v37
    v_add_f32 v38, v38, v40
    v_add_f32 v39, v39, v41
    v_add_f32 v18, v18, v22
    v_add_f32 v19, v19, v23
    v_add_f32 v26, v26, v30
    v_add_f32 v27, v27, v31
    v_add_f32 v34, v34, v38
    v_add_f32 v35, v35, v39
    v_add_f32 v18, v18, v26
    v_add_f32 v19, v19, v27
    v_add_f32 v18, v18, v34
    v_add_f32 v19, v19, v35
    v_mov_b32 v20, v19
    v_mov_b32 v19, s26
    v_mov_b32 v21, s26
    v_lshrrev_b32 v14, 3, v0
    v_and_b32 v15, 7, v0
    v_lshlrev_b32 v14, 12, v14
    v_lshl_add_u32 v14, v15, 4, v14
    s_cmp_eq_u32 s78, 0
    s_cbranch_scc1 L_sta_f
    buffer_store_dwordx4 v[18:21], v14, s[60:63], s83 offen sc1
    s_branch L_sta_g
L_sta_f:
    s_nop 4
    buffer_store_dwordx4 v[18:21], v14, s[60:63], s83 offen
L_sta_g:
    s_nop 4
    s_waitcnt vmcnt(0)
L_y_done:
    s_nop 4
    s_barrier
    s_cmp_eq_u32 s64, 1
    s_cbranch_scc1 L_final
    s_sub_u32 s79, s64, 2
    s_cmp_gt_u32 s79, 3
    s_cbranch_scc1 L_fin_skip
    s_lshr_b32 s75, s79, 1
    s_lshl_b32 s75, s75, 5
    s_add_u32 s75, s75, s66
    s_cmp_ge_u32 s75, 40
    s_cbranch_scc1 L_fin_skip
    s_and_b32 s79, s79, 1
    s_mul_i32 s88, s65, 40
    s_add_u32 s88, s88, s75
    s_lshl_b32 s88, s88, 12
    s_mul_i32 s74, s79, 2097152
    s_add_u32 s88, s88, s74
    s_add_u32 s88, s88, 2097152
    v_lshlrev_b32 v120, 4, v1
    v_mov_b32 v121, 0x70000000
    s_lshl_b32 s74, s75, 3
    v_add_u32 v98, s74, v1
    v_lshrrev_b32 v99, 1, v98
    v_lshlrev_b32 v99, 9, v99
    v_and_b32 v98, 1, v98
    v_lshl_add_u32 v99, v98, 4, v99
    v_cmp_gt_u32 vcc, 8, v1
    s_nop 1
    v_cndmask_b32 v99, v121, v99, vcc
    s_lshl_b32 s74, s65, 6
    s_lshl_b32 s79, s79, 5
    s_add_u32 s74, s74, s79
    s_add_u32 s74, s74, 7340032
    s_mov_b32 s92, 20000
L_rc:
    s_nop 4
    s_cmp_eq_u32 s78, 0
    s_cbranch_scc1 L_rcm_f
    buffer_load_dwordx4 v[8:11], v120, s[60:63], s88 offen offset:0 sc1
    buffer_load_dwordx4 v[12:15], v120, s[60:63], s88 offen offset:1024 sc1
    buffer_load_dwordx4 v[16:19], v120, s[60:63], s88 offen offset:2048 sc1
    buffer_load_dwordx4 v[20:23], v120, s[60:63], s88 offen offset:3072 sc1
    s_branch L_rcm_g
L_rcm_f:
    s_nop 4
    buffer_load_dwordx4 v[8:11], v120, s[60:63], s88 offen offset:0 nt
    buffer_load_dwordx4 v[12:15], v120, s[60:63], s88 offen offset:1024 nt
    buffer_load_dwordx4 v[16:19], v120, s[60:63], s88 offen offset:2048 nt
    buffer_load_dwordx4 v[20:23], v120, s[60:63], s88 offen offset:3072 nt
L_rcm_g:
    s_nop 4
    s_waitcnt vmcnt(0)
    v_xor_b32 v96, s26, v9
    v_xor_b32 v97, s26, v11
    v_or_b32 v96, v96, v97
    v_xor_b32 v97, s26, v13
    v_or_b32 v96, v96, v97
    v_xor_b32 v97, s26, v15
    v_or_b32 v96, v96, v97
    v_xor_b32 v97, s26, v17
    v_or_b32 v96, v96, v97
    v_xor_b32 v97, s26, v19
    v_or_b32 v96, v96, v97
    v_xor_b32 v97, s26, v21
    v_or_b32 v96, v96, v97
    v_xor_b32 v97, s26, v23
    v_or_b32 v96, v96, v97
    v_cmp_eq_u32 s[94:95], 0, v96
    s_nop 4
    s_cmp_eq_u64 s[94:95], exec
    s_cbranch_scc1 L_rc_ok
    s_sub_u32 s92, s92, 1
    s_cbranch_scc1 L_rc_ok
    s_sleep 2
    s_branch L_rc
L_rc_ok:
    s_nop 4
    v_add_f32 v8, v8, v12
    v_add_f32 v16, v16, v20
    v_add_f32 v10, v10, v14
    v_add_f32 v18, v18, v22
    v_add_f32 v8, v8, v16
    v_add_f32 v10, v10, v18
    s_nop 0
    v_add_f32_dpp v8, v8, v8 row_ror:8 row_mask:0xf bank_mask:0xf
    v_add_f32_dpp v10, v10, v10 row_ror:8 row_mask:0xf bank_mask:0xf
    v_mov_b32 v12, v8
    v_mov_b32 v13, v10
    s_nop 0
    v_permlane16_swap_b32 v8, v12
    v_permlane16_swap_b32 v10, v13
    v_add_f32 v8, v8, v12
    v_add_f32 v10, v10, v13
    v_mov_b32 v12, v8
    v_mov_b32 v13, v10
    s_nop 0
    v_permlane32_swap_b32 v8, v12
    v_permlane32_swap_b32 v10, v13
    v_add_f32 v8, v8, v12
    v_add_f32 v10, v10, v13
    v_mov_b32 v9, s26
    v_mov_b32 v11, s26
    buffer_store_dwordx4 v[8:11], v99, s[60:63], s74 offen sc1
    s_branch L_fin_skip
L_final:
    s_nop 4
    s_cmp_ge_u32 s69, 160
    s_cbranch_scc1 L_fin_skip
    v_lshlrev_b32 v120, 4, v1
    v_mov_b32 v121, 0x70000000
    v_cmp_le_u32 s[72:73], 32, v1
    s_nop 1
    v_cndmask_b32 v120, v120, v121, s[72:73]
    s_lshl_b32 s88, s69, 9
    s_add_u32 s88, s88, 7340032
    v_and_b32 v104, 3, v1
    v_lshlrev_b32 v104, 1, v104
    s_lshl_b32 s93, s69, 3
    buffer_load_ushort v105, v104, s[28:31], s93 offen
    s_mov_b32 s92, 20000
L_fpoll:
    s_nop 4
    buffer_load_dwordx4 v[8:11], v120, s[60:63], s88 offen sc1
    s_waitcnt vmcnt(0)
    v_xor_b32 v96, s26, v9
    v_xor_b32 v97, s26, v11
    v_or_b32 v96, v96, v97
    v_cmp_eq_u32 s[94:95], 0, v96
    s_nop 4
    s_or_b64 s[94:95], s[94:95], s[72:73]
    s_nop 4
    s_cmp_eq_u64 s[94:95], exec
    s_cbranch_scc1 L_fpoll_ok
    s_sub_u32 s92, s92, 1
    s_cbranch_scc1 L_fpoll_ok
    s_sleep 2
    s_branch L_fpoll
L_fpoll_ok:
    s_nop 4
    v_add_f32_dpp v8, v8, v8 row_ror:4 row_mask:0xf bank_mask:0xf
    v_add_f32_dpp v10, v10, v10 row_ror:4 row_mask:0xf bank_mask:0xf
    s_nop 0
    v_add_f32_dpp v8, v8, v8 row_ror:8 row_mask:0xf bank_mask:0xf
    v_add_f32_dpp v10, v10, v10 row_ror:8 row_mask:0xf bank_mask:0xf
    v_mov_b32 v12, v8
    v_mov_b32 v13, v10
    s_nop 0
    v_permlane16_swap_b32 v8, v12
    v_permlane16_swap_b32 v10, v13
    v_add_f32 v8, v8, v12
    v_add_f32 v10, v10, v13
    v_and_b32 v96, 1, v1
    v_cmp_eq_u32 vcc, 1, v96
    v_mov_b32_dpp v12, v8 quad_perm:[0,0,1,1] row_mask:0xf bank_mask:0xf
    v_mov_b32_dpp v13, v10 quad_perm:[0,0,1,1] row_mask:0xf bank_mask:0xf
    v_mov_b32_dpp v14, v8 quad_perm:[2,2,3,3] row_mask:0xf bank_mask:0xf
    v_mov_b32_dpp v15, v10 quad_perm:[2,2,3,3] row_mask:0xf bank_mask:0xf
    v_cndmask_b32 v112, v12, v13, vcc
    v_cndmask_b32 v108, v14, v15, vcc
    v_cvt_pk_bf16_f32 v97, v112, v108
    v_lshlrev_b32 v112, 16, v97
    v_and_b32 v108, 0xffff0000, v97
    v_lshlrev_b32 v105, 16, v105
    v_add_f32 v112, v105, v112
    v_cvt_pk_bf16_f32 v97, v112, v113
    v_lshlrev_b32 v112, 16, v97
    v_and_b32 v113, 0xffff0000, v97
    v_add_f32 v112, v112, v108
    v_cvt_pk_bf16_f32 v112, v112, v112
    v_mov_b32 v97, 0x70000000
    v_cmp_gt_u32 vcc, 4, v1
    s_nop 1
    v_cndmask_b32 v104, v97, v104, vcc
    buffer_store_short v112, v104, s[56:59], s93 offen
    s_cmp_lg_u32 s69, 0
    s_cbranch_scc1 L_fin_skip
    v_mov_b32 v98, s26
    v_mov_b32 v99, 0
    v_cmp_eq_u32 vcc, 0, v1
    s_nop 1
    v_cndmask_b32 v99, v97, v99, vcc
    buffer_store_dword v98, v99, s[60:63], 0 offen
L_fin_skip:
    s_nop 4
L_end:
    s_endpgm
.section .rodata,"a"
.p2align 6
.amdhsa_kernel parallel_sum__sliding_block_cached__dense_activation_relu__decode_kernel
  .amdhsa_next_free_vgpr 128
  .amdhsa_next_free_sgpr 96
  .amdhsa_accum_offset 128
  .amdhsa_group_segment_fixed_size 0
  .amdhsa_kernarg_size 88
  .amdhsa_user_sgpr_count 2
  .amdhsa_user_sgpr_kernarg_segment_ptr 1
  .amdhsa_system_sgpr_workgroup_id_x 1
.end_amdhsa_kernel
```
